```python
import torch

def _softmax(x, axis=-1):
    return torch.softmax(x, dim=axis)
def _gelu(x):
    return torch.nn.functional.gelu(x, approximate="tanh")
def _silu(x):
    return torch.nn.functional.silu(x)
def _sigmoid(x):
    return torch.sigmoid(x)
def _layernorm(x, axis=-1, eps=1e-5):
    m = x.mean(dim=axis, keepdim=True)
    v = x.var(dim=axis, keepdim=True, unbiased=False)
    return (x - m) / torch.sqrt(v + eps)
def _scatter_add(tgt, idx, src, axis=0):
    return tgt.clone().index_add_(axis, idx, src)
def _segment_sum(src, seg, n):
    out = torch.zeros((n,) + src.shape[1:], dtype=src.dtype)
    return out.index_add_(0, seg, src)
def _pad(x, pw):
    flat = tuple(v for pair in reversed(pw) for v in pair)
    return torch.nn.functional.pad(x, flat)

kernel_name = 'recurrent_scan__gqa_block_cached__swiglu_ffn__decode'

def setup_inputs():

    _w = (lambda a: (lambda t: t.to(torch.bfloat16) if t.is_floating_point() else t)(torch.as_tensor(a)))
    def _A_setup():
        B, Sq, D = 1, 1, 1024
        Hq, Hkv, Sk, Dh = 32, 4, 32768, 128
        assert Hq % Hkv == 0, (Hq, Hkv)
        return {
            "x": _w((lambda *s: torch.randn(*s, dtype=torch.bfloat16) * 0.05)(B, Sq, D)),
            "k_cache": _w((lambda *s: torch.randn(*s, dtype=torch.bfloat16) * 1.6)(B, Hkv, Sk, Dh)),
            "v_cache": _w((lambda *s: torch.randn(*s, dtype=torch.bfloat16) * 0.2)(B, Hkv, Sk, Dh)),
            "wq": _w((lambda *s: torch.randn(*s, dtype=torch.bfloat16) * 1.6)(D, Hq * Dh) * (D ** -0.5)),
            "wo": _w((lambda *s: torch.randn(*s, dtype=torch.bfloat16) * 0.2)(Hq * Dh, D) * ((Hq * Dh) ** -0.5)),
        }
    _A_in = _A_setup()

    def _B_setup():
        B, S, D, F = 1, 1, 1024, 3584
        return {
            "x": _w((lambda *s: torch.randn(*s, dtype=torch.bfloat16) * 0.05)(B, S, D)),
            "w_gate": _w((lambda *s: torch.randn(*s, dtype=torch.bfloat16) * 0.1)(D, F)),
            "w_up": _w((lambda *s: torch.randn(*s, dtype=torch.bfloat16) * 0.1)(D, F)),
            "w_down": _w((lambda *s: torch.randn(*s, dtype=torch.bfloat16) * 0.1)(F, D)),
        }
    _B_in = _B_setup()

    return {
        "A_x": _A_in["x"],
        "A_k_cache": _A_in["k_cache"],
        "A_v_cache": _A_in["v_cache"],
        "A_wq": _A_in["wq"],
        "A_wo": _A_in["wo"],
        "B_x": _B_in["x"],
        "B_w_gate": _B_in["w_gate"],
        "B_w_up": _B_in["w_up"],
        "B_w_down": _B_in["w_down"],
    }

def reference(A_x, A_k_cache, A_v_cache, A_wq, A_wo, B_x, B_w_gate, B_w_up, B_w_down):
    def _A_ref(x, k_cache, v_cache, wq, wo):
        B, Sq, D = x.shape
        Hq, Dh = 32, 128
        Hkv = k_cache.shape[1]
        rep = Hq // Hkv
        q = (lambda x, *d: x.permute(*d))((x @ wq).reshape(B, Sq, Hq, Dh), 0, 2, 1, 3)
        k = (lambda x, n, axis: torch.repeat_interleave(x, n, dim=axis))(k_cache, rep, axis=1)
        v = (lambda x, n, axis: torch.repeat_interleave(x, n, dim=axis))(v_cache, rep, axis=1)
        scores = torch.einsum("bhqd,bhkd->bhqk", q, k) * (Dh ** -0.5)
        p = _softmax(scores, axis=-1)
        o = torch.einsum("bhqk,bhkd->bhqd", p, v)
        return (lambda x, *d: x.permute(*d))(o, 0, 2, 1, 3).reshape(B, Sq, Hq * Dh) @ wo

    def _B_ref(x, w_gate, w_up, w_down):
        g = _silu(x @ w_gate)
        u = x @ w_up
        return (g * u) @ w_down

    x = A_x
    xn = _layernorm(x, axis=-1)
    s = _A_ref(xn, A_k_cache, A_v_cache, A_wq, A_wo)
    g = _silu(_B_ref(xn, B_w_gate, B_w_up, B_w_down))
    return x + s * g
```

```asm
; @launch grid=(256,1,1) block=(512,1,1) lds=146176
.amdgcn_target "amdgcn-amd-amdhsa--gfx950"
.text

.globl recurrent_scan__gqa_block_cached__swiglu_ffn__decode_kernel
.p2align 8
.type recurrent_scan__gqa_block_cached__swiglu_ffn__decode_kernel,@function
recurrent_scan__gqa_block_cached__swiglu_ffn__decode_kernel:
    s_cmp_ge_u32 s2, 256
    s_cbranch_scc1 L_end
    s_load_dwordx16 s[16:31], s[0:1], 0
    s_load_dwordx8 s[32:39], s[0:1], 64
    s_getpc_b64 s[4:5]
L_pc:
    v_subrev_u32 v12, 64, v0
    v_mov_b32 v13, 0
    v_cmp_gt_u32 vcc, (L_codeend-L_pc)/128, v12
    v_lshlrev_b32 v12, 7, v12
    s_and_saveexec_b64 s[6:7], vcc
    s_cbranch_execz L_nopf
    v_lshl_add_u64 v[12:13], v[12:13], 0, s[4:5]
    global_load_dword v16, v[12:13], off offset:64
L_nopf:
    s_mov_b64 exec, -1
    v_cmp_gt_u32 vcc, 64, v0
    v_lshrrev_b32 v1, 6, v0
    v_and_b32 v0, 63, v0
    v_lshrrev_b32 v2, 3, v0
    v_and_b32 v3, 7, v0
    v_lshrrev_b32 v4, 4, v0
    s_and_b32 s14, s2, 3
    s_mov_b32 s43, 0x20000
    s_cbranch_vccz L_others
    s_setprio 3
    v_lshrrev_b32 v12, 5, v0
    v_and_b32 v13, 3, v2
    v_lshl_add_u32 v12, v12, 3, v13
    v_lshlrev_b32 v13, 1, v4
    v_xor_b32 v13, v13, v3
    v_lshlrev_b32 v13, 4, v13
    v_lshl_add_u32 v16, v12, 13, v13
    s_lshl_b32 s8, s14, 21
    s_lshr_b32 s5, s2, 3
    s_lshl_b32 s4, s2, 1
    s_and_b32 s4, s4, 8
    s_xor_b32 s5, s5, s4
    s_xor_b32 s5, s5, 4
    s_and_b32 s5, s5, 15
    s_lshr_b32 s4, s2, 6
    s_lshl4_add_u32 s5, s4, s5
    s_lshl_b32 s5, s5, 7
    s_add_u32 s8, s8, s5
    s_mov_b32 m0, 0
    s_mov_b32 s42, 8388608
    s_waitcnt lgkmcnt(0)
    s_mov_b64 s[40:41], s[22:23]
L_ld_q:
    buffer_load_dwordx4 v16, s[40:43], s8 offen offset:0 nt lds
    s_add_u32 s9, s8, 130048
    buffer_load_dwordx4 v16, s[40:43], s9 offen offset:1024 nt lds
    s_add_u32 s9, s8, 30720
    buffer_load_dwordx4 v16, s[40:43], s9 offen offset:2048 nt lds
    s_add_u32 s9, s8, 160768
    buffer_load_dwordx4 v16, s[40:43], s9 offen offset:3072 nt lds
    s_add_u32 s8, s8, 262144
    s_add_u32 m0, m0, 4096
    s_cmp_lt_u32 m0, 0x8000
    s_cbranch_scc1 L_ld_q
    s_branch L_loader
L_others:
    v_readfirstlane_b32 s3, v1
    v_lshlrev_b32 v14, 4, v0
    v_lshlrev_b32 v15, 3, v0
    s_lshl_b32 s10, s14, 9
    s_movk_i32 s42, 2048
    s_xor_b32 s3, s3, 4
    s_cmp_gt_u32 s3, 3
    v_mov_b32 v1, 131072
    v_mov_b32 v28, 0
    v_mov_b32 v29, 0
    v_mov_b32 v30, 0
    v_mov_b32 v31, 0
    v_lshl_add_u32 v12, v0, 4, v1
    ds_write_b128 v12, v[28:31] offset:4352
    v_lshl_add_u32 v13, v0, 2, v1
    v_mov_b32 v27, -1
    ds_write_b32 v13, v30 offset:512
    ds_write2_b32 v1, v30, v27 offset0:0 offset1:1
    s_waitcnt lgkmcnt(0)
    s_mov_b64 s[40:41], s[16:17]
    s_load_dword s13, s[38:39], 258048
    s_cbranch_scc1 L_nox
    buffer_load_dwordx4 v[56:59], v14, s[40:43], 0 offen
    buffer_load_dwordx4 v[60:63], v14, s[40:43], 0 offen offset:1024
    buffer_load_dwordx2 v[64:65], v15, s[40:43], s10 offen
L_nox:
    s_waitcnt lgkmcnt(0)
    s_barrier
    s_branch L_notloader
L_loader:
    v_mov_b32 v1, 131072
    v_mov_b32 v30, 0
    v_mov_b32 v31, -1
    s_barrier
    v_lshl_add_u32 v29, v0, 3, v1
    s_movk_i32 s7, 7168
    v_mad_u32_u24 v40, v12, s7, v13
    v_add_u32 v41, 113664, v40
    v_add_u32 v42, 26624, v40
    v_add_u32 v43, 140288, v40
    s_lshr_b32 s4, s2, 6
    s_mul_i32 s4, s4, 56
    s_and_b32 s5, s2, 63
    s_add_u32 s4, s4, s5
    s_lshr_b32 s6, s4, 2
    s_mov_b32 s12, 3584
    s_cmp_ge_u32 s6, 28
    s_cselect_b32 s12, 4294963712, s12
    s_lshl_b32 s6, s6, 7
    s_mul_i32 s7, s14, 1835008
    s_add_u32 s8, s7, s6
    s_mov_b32 s42, 7340032
    s_mov_b64 s[40:41], s[28:29]
    s_mov_b32 s98, 2
    s_cmp_ge_u32 s5, 56
    v_add_u32 v30, 1, v30
    s_waitcnt vmcnt(28)
    ds_write_b64 v29, v[30:31] offset:0
    v_add_u32 v30, 1, v30
    s_waitcnt vmcnt(24)
    ds_write_b64 v29, v[30:31] offset:0
    s_cbranch_scc1 L_ld_kv
    s_add_u32 s12, s12, s8
    s_mov_b32 s6, 0x10000
    s_mov_b32 s98, 6
L_ld_gu:
    s_waitcnt vmcnt(21)
    buffer_load_dwordx4 v40, s[40:43], s8 offen offset:0 nt lds
    v_add_u32 v30, 1, v30
    s_waitcnt vmcnt(21)
    ds_write_b64 v29, v[30:31] offset:0
    buffer_load_dwordx4 v41, s[40:43], s8 offen offset:1024 nt lds
    s_waitcnt vmcnt(21)
    buffer_load_dwordx4 v42, s[40:43], s8 offen offset:2048 nt lds
    s_waitcnt vmcnt(21)
    buffer_load_dwordx4 v43, s[40:43], s8 offen offset:3072 nt lds
    s_add_u32 m0, m0, 4096
    s_add_u32 s8, s8, 229376
    s_cmp_lt_u32 m0, s6
    s_cbranch_scc1 L_ld_gu
    s_mov_b32 s8, s12
    s_mov_b64 s[40:41], s[30:31]
    s_mov_b32 s6, 0x18000
    s_cmp_lt_u32 m0, s6
    s_cbranch_scc1 L_ld_gu
L_ld_kv:
    ds_read_b128 v[32:35], v1 offset:512
    ds_read_b32 v37, v1 offset:4352
    v_mov_b32 v36, v1
    v_and_b32 v5, 15, v0
    v_add_u32 v14, 0, v4
    v_lshlrev_b32 v14, 1, v14
    v_xor_b32 v14, v14, v5
    v_lshlrev_b32 v14, 4, v14
    v_lshl_add_u32 v24, v4, 8, v14
    v_add_u32 v14, 4, v4
    v_lshlrev_b32 v14, 1, v14
    v_xor_b32 v14, v14, v5
    v_lshlrev_b32 v14, 4, v14
    v_lshl_add_u32 v25, v4, 8, v14
    s_mov_b64 s[44:45], s[18:19]
    s_mov_b32 s46, 33554432
    s_mov_b32 s47, 0x20000
    s_mov_b64 s[48:49], s[20:21]
    s_mov_b32 s50, 33554432
    s_mov_b32 s51, 0x20000
    s_mov_b32 s10, 0
    s_mov_b32 s11, 0
    s_mov_b32 s15, 0
    s_mov_b32 s60, 2000000
    s_branch L_ld_chk
L_ld_tile:
    s_and_b32 s8, s7, 0xffffe000
    s_bitcmp1_b32 s7, 2
    s_cselect_b64 s[44:45], s[20:21], s[18:19]
    s_waitcnt vmcnt(21)
    buffer_load_dwordx4 v24, s[44:47], s8 offen offset:0 nt lds
    v_add_u32 v30, 1, v30
    s_waitcnt vmcnt(21)
    ds_write_b64 v29, v[30:31] offset:0
    buffer_load_dwordx4 v25, s[44:47], s8 offen offset:1024 nt lds
    s_waitcnt vmcnt(21)
    buffer_load_dwordx4 v24, s[44:47], s8 offen offset:2048 nt lds
    s_waitcnt vmcnt(21)
    buffer_load_dwordx4 v25, s[44:47], s8 offen offset:3072 nt lds
    s_add_u32 m0, m0, 4096
    s_add_u32 s9, s8, 4096
    s_bfe_u32 s4, s7, 0x10001
    s_and_b32 s5, s11, 1
    s_lshl_b32 s4, s4, s5
    s_or_b32 s15, s15, s4
    s_add_u32 s11, s11, 1
    s_xor_b32 s5, s5, 1
    s_bitcmp1_b32 s15, s5
    s_addc_u32 s11, s11, 0
    v_mov_b32 v38, s11
    ds_write_b32 v1, v38 offset:540
    s_waitcnt vmcnt(21)
    buffer_load_dwordx4 v24, s[44:47], s9 offen offset:0 nt lds
    v_add_u32 v30, 1, v30
    s_waitcnt vmcnt(21)
    ds_write_b64 v29, v[30:31] offset:0
    buffer_load_dwordx4 v25, s[44:47], s9 offen offset:1024 nt lds
    s_waitcnt vmcnt(21)
    buffer_load_dwordx4 v24, s[44:47], s9 offen offset:2048 nt lds
    s_waitcnt vmcnt(21)
    buffer_load_dwordx4 v25, s[44:47], s9 offen offset:3072 nt lds
    s_add_u32 m0, m0, 4096
    v_lshl_add_u32 v36, v38, 2, v1
    s_add_u32 s10, s10, 1
    s_cmp_eq_u32 s15, 3
    s_cselect_b32 s4, s10, -1
    v_mov_b32 v31, s4
    s_cselect_b32 s4, 4, 1
    s_add_u32 s98, s98, s4
    s_bitcmp1_b32 s7, 3
    s_cselect_b64 s[48:49], s[18:19], s[20:21]
    s_and_b32 s4, s7, 12
    s_cselect_b32 s4, 8192, 0
    s_add_u32 s8, s8, s4
    s_add_u32 s9, s9, s4
    s_waitcnt vmcnt(21)
    buffer_load_dwordx4 v24, s[48:51], s8 offen offset:0 nt lds
    v_add_u32 v30, 1, v30
    s_waitcnt vmcnt(21)
    ds_write_b64 v29, v[30:31] offset:0
    buffer_load_dwordx4 v25, s[48:51], s8 offen offset:1024 nt lds
    s_waitcnt vmcnt(21)
    buffer_load_dwordx4 v24, s[48:51], s8 offen offset:2048 nt lds
    s_waitcnt vmcnt(21)
    buffer_load_dwordx4 v25, s[48:51], s8 offen offset:3072 nt lds
    s_add_u32 m0, m0, 4096
    ds_read_b128 v[32:35], v1 offset:512
    ds_read_b32 v37, v36 offset:4352
    s_waitcnt vmcnt(21)
    buffer_load_dwordx4 v24, s[48:51], s9 offen offset:0 nt lds
    v_add_u32 v30, 1, v30
    s_waitcnt vmcnt(21)
    ds_write_b64 v29, v[30:31] offset:0
    buffer_load_dwordx4 v25, s[48:51], s9 offen offset:1024 nt lds
    s_waitcnt vmcnt(21)
    buffer_load_dwordx4 v24, s[48:51], s9 offen offset:2048 nt lds
    s_waitcnt vmcnt(21)
    buffer_load_dwordx4 v25, s[48:51], s9 offen offset:3072 nt lds
    s_add_u32 m0, m0, 4096
    s_and_b32 m0, m0, 0x1ffff
    s_mov_b32 s60, 2000000
L_ld_chk:
    s_waitcnt lgkmcnt(0)
    v_min3_u32 v32, v32, v33, v34
    v_readfirstlane_b32 s5, v37
    v_min_u32 v32, v32, v35
    s_cmp_eq_u32 s15, 3
    v_readfirstlane_b32 s4, v32
    s_cbranch_scc1 L_ld_end
    s_add_u32 s4, s4, 8
    s_cmp_gt_u32 s4, s98
    s_cselect_b32 s7, s5, 0
    s_bitcmp1_b32 s7, 0
    s_cbranch_scc1 L_ld_tile
L_ld_again:
    s_cmp_eq_u32 s15, 3
    s_cselect_b32 s5, 0, s5
    s_cmp_lg_u32 s5, 2
    s_cbranch_scc1 L_ld_peek
    s_and_b32 s5, s11, 1
    s_bitset1_b32 s15, s5
    s_add_u32 s11, s11, 1
    v_mov_b32 v32, s11
    v_lshl_add_u32 v36, v32, 2, v1
    ds_write_b32 v1, v32 offset:540
    s_cmp_eq_u32 s15, 3
    s_cbranch_scc0 L_ld_peek
    v_mov_b32 v31, s10
    s_add_u32 s98, s98, 3
    s_cmp_gt_u32 s4, s98
    s_cbranch_scc1 L_ld_go
L_ld_peek:
    ds_read_b128 v[32:35], v1 offset:512
    ds_read_b32 v37, v36 offset:4352
    s_sub_u32 s60, s60, 1
    s_cbranch_scc0 L_ld_chk
    v_mov_b32 v30, 0x7fffffff
    v_mov_b32 v31, s10
    ds_write_b64 v29, v[30:31] offset:0
    s_endpgm
L_ld_end:
    s_add_u32 s4, s4, 8
    s_cmp_gt_u32 s4, s98
    s_cbranch_scc0 L_ld_again
L_ld_go:
    v_lshl_add_u32 v44, v12, 11, v13
    v_add_u32 v45, 31744, v44
    v_add_u32 v46, 6144, v44
    v_add_u32 v47, 37888, v44
    s_mov_b64 s[52:53], s[32:33]
    s_mov_b32 s54, 7340032
    s_mov_b32 s55, 0x20000
    s_lshr_b32 s62, s2, 7
    s_lshl_b32 s62, s62, 3
    s_and_b32 s6, s2, 7
    s_or_b32 s6, s6, s62
    s_mul_i32 s96, s6, 458752
    s_bfe_u32 s6, s2, 0x40003
    s_lshl_b32 s6, s6, 7
    s_add_u32 s96, s96, s6
    s_waitcnt vmcnt(21)
    buffer_load_dwordx4 v44, s[52:55], s96 offen offset:0 nt lds
    v_add_u32 v30, 1, v30
    s_waitcnt vmcnt(21)
    ds_write_b64 v29, v[30:31] offset:0
    buffer_load_dwordx4 v45, s[52:55], s96 offen offset:1024 nt lds
    s_waitcnt vmcnt(21)
    buffer_load_dwordx4 v46, s[52:55], s96 offen offset:2048 nt lds
    s_waitcnt vmcnt(21)
    buffer_load_dwordx4 v47, s[52:55], s96 offen offset:3072 nt lds
    s_add_u32 m0, m0, 4096
    s_add_u32 s96, s96, 0x10000
    s_waitcnt vmcnt(21)
    buffer_load_dwordx4 v44, s[52:55], s96 offen offset:0 nt lds
    v_add_u32 v30, 1, v30
    s_waitcnt vmcnt(21)
    ds_write_b64 v29, v[30:31] offset:0
    buffer_load_dwordx4 v45, s[52:55], s96 offen offset:1024 nt lds
    s_waitcnt vmcnt(21)
    buffer_load_dwordx4 v46, s[52:55], s96 offen offset:2048 nt lds
    s_waitcnt vmcnt(21)
    buffer_load_dwordx4 v47, s[52:55], s96 offen offset:3072 nt lds
    s_add_u32 m0, m0, 4096
    s_add_u32 s96, s96, 0x10000
    s_mov_b64 s[56:57], s[24:25]
    s_mov_b32 s58, 8388608
    s_mov_b32 s59, 0x20000
    s_waitcnt vmcnt(21)
    buffer_load_dwordx4 v44, s[52:55], s96 offen offset:0 nt lds
    v_add_u32 v30, 1, v30
    s_waitcnt vmcnt(21)
    ds_write_b64 v29, v[30:31] offset:0
    buffer_load_dwordx4 v45, s[52:55], s96 offen offset:1024 nt lds
    s_waitcnt vmcnt(21)
    buffer_load_dwordx4 v46, s[52:55], s96 offen offset:2048 nt lds
    s_waitcnt vmcnt(21)
    buffer_load_dwordx4 v47, s[52:55], s96 offen offset:3072 nt lds
    s_add_u32 m0, m0, 4096
    s_add_u32 s96, s96, 0x10000
    s_and_b32 s6, s2, 7
    s_lshr_b32 s62, s2, 5
    s_lshl_b32 s62, s62, 3
    s_or_b32 s6, s6, s62
    s_bfe_u32 s7, s2, 0x20003
    s_waitcnt vmcnt(21)
    buffer_load_dwordx4 v44, s[52:55], s96 offen offset:0 nt lds
    v_add_u32 v30, 1, v30
    s_waitcnt vmcnt(21)
    ds_write_b64 v29, v[30:31] offset:0
    buffer_load_dwordx4 v45, s[52:55], s96 offen offset:1024 nt lds
    s_waitcnt vmcnt(21)
    buffer_load_dwordx4 v46, s[52:55], s96 offen offset:2048 nt lds
    s_waitcnt vmcnt(21)
    buffer_load_dwordx4 v47, s[52:55], s96 offen offset:3072 nt lds
    s_add_u32 m0, m0, 4096
    s_add_u32 s96, s96, 0x10000
    s_and_b32 m0, m0, 0x1ffff
    s_waitcnt vmcnt(21)
    buffer_load_dwordx4 v44, s[52:55], s96 offen offset:0 nt lds
    v_add_u32 v30, 1, v30
    s_waitcnt vmcnt(21)
    ds_write_b64 v29, v[30:31] offset:0
    buffer_load_dwordx4 v45, s[52:55], s96 offen offset:1024 nt lds
    s_waitcnt vmcnt(21)
    buffer_load_dwordx4 v46, s[52:55], s96 offen offset:2048 nt lds
    s_waitcnt vmcnt(21)
    buffer_load_dwordx4 v47, s[52:55], s96 offen offset:3072 nt lds
    s_add_u32 m0, m0, 4096
    s_add_u32 s96, s96, 0x10000
    s_lshl_b32 s6, s6, 17
    s_lshl_b32 s7, s7, 9
    s_add_u32 s97, s6, s7
    s_waitcnt vmcnt(21)
    buffer_load_dwordx4 v44, s[52:55], s96 offen offset:0 nt lds
    v_add_u32 v30, 1, v30
    s_waitcnt vmcnt(21)
    ds_write_b64 v29, v[30:31] offset:0
    buffer_load_dwordx4 v45, s[52:55], s96 offen offset:1024 nt lds
    s_waitcnt vmcnt(21)
    buffer_load_dwordx4 v46, s[52:55], s96 offen offset:2048 nt lds
    s_waitcnt vmcnt(21)
    buffer_load_dwordx4 v47, s[52:55], s96 offen offset:3072 nt lds
    s_add_u32 m0, m0, 4096
    s_add_u32 s96, s96, 0x10000
    s_waitcnt vmcnt(21)
    buffer_load_dwordx4 v44, s[52:55], s96 offen offset:0 nt lds
    v_add_u32 v30, 1, v30
    s_waitcnt vmcnt(21)
    ds_write_b64 v29, v[30:31] offset:0
    buffer_load_dwordx4 v45, s[52:55], s96 offen offset:1024 nt lds
    s_waitcnt vmcnt(21)
    buffer_load_dwordx4 v46, s[52:55], s96 offen offset:2048 nt lds
    s_waitcnt vmcnt(21)
    buffer_load_dwordx4 v47, s[52:55], s96 offen offset:3072 nt lds
    s_add_u32 m0, m0, 4096
    s_waitcnt vmcnt(21)
    buffer_load_dwordx4 v44, s[56:59], s97 offen offset:0 nt lds
    v_add_u32 v30, 1, v30
    s_waitcnt vmcnt(21)
    ds_write_b64 v29, v[30:31] offset:0
    buffer_load_dwordx4 v45, s[56:59], s97 offen offset:1024 nt lds
    s_waitcnt vmcnt(21)
    buffer_load_dwordx4 v46, s[56:59], s97 offen offset:2048 nt lds
    s_waitcnt vmcnt(21)
    buffer_load_dwordx4 v47, s[56:59], s97 offen offset:3072 nt lds
    s_add_u32 m0, m0, 4096
    s_add_u32 s97, s97, 128
    s_and_b32 m0, m0, 0x1ffff
    s_nop 0
    buffer_load_dwordx4 v44, s[56:59], s97 offen offset:0 nt lds
    buffer_load_dwordx4 v45, s[56:59], s97 offen offset:1024 nt lds
    buffer_load_dwordx4 v46, s[56:59], s97 offen offset:2048 nt lds
    buffer_load_dwordx4 v47, s[56:59], s97 offen offset:3072 nt lds
    s_add_u32 m0, m0, 4096
    s_add_u32 s97, s97, 128
    buffer_load_dwordx4 v44, s[56:59], s97 offen offset:0 nt lds
    buffer_load_dwordx4 v45, s[56:59], s97 offen offset:1024 nt lds
    buffer_load_dwordx4 v46, s[56:59], s97 offen offset:2048 nt lds
    buffer_load_dwordx4 v47, s[56:59], s97 offen offset:3072 nt lds
    s_add_u32 m0, m0, 4096
    s_add_u32 s97, s97, 128
    s_waitcnt vmcnt(29)
    buffer_load_dwordx4 v44, s[56:59], s97 offen offset:0 nt lds
    v_add_u32 v30, 1, v30
    s_waitcnt vmcnt(29)
    ds_write_b64 v29, v[30:31] offset:0
    buffer_load_dwordx4 v45, s[56:59], s97 offen offset:1024 nt lds
    s_waitcnt vmcnt(29)
    buffer_load_dwordx4 v46, s[56:59], s97 offen offset:2048 nt lds
    s_waitcnt vmcnt(29)
    buffer_load_dwordx4 v47, s[56:59], s97 offen offset:3072 nt lds
    s_add_u32 m0, m0, 4096
    s_add_u32 s97, s97, 65152
    s_waitcnt vmcnt(29)
    buffer_load_dwordx4 v44, s[56:59], s97 offen offset:0 nt lds
    v_add_u32 v30, 1, v30
    s_waitcnt vmcnt(29)
    ds_write_b64 v29, v[30:31] offset:0
    buffer_load_dwordx4 v45, s[56:59], s97 offen offset:1024 nt lds
    s_waitcnt vmcnt(29)
    buffer_load_dwordx4 v46, s[56:59], s97 offen offset:2048 nt lds
    s_waitcnt vmcnt(29)
    buffer_load_dwordx4 v47, s[56:59], s97 offen offset:3072 nt lds
    s_add_u32 m0, m0, 4096
    s_add_u32 s97, s97, 128
    s_and_b32 m0, m0, 0x1ffff
    s_waitcnt vmcnt(29)
    buffer_load_dwordx4 v44, s[56:59], s97 offen offset:0 nt lds
    v_add_u32 v30, 1, v30
    s_waitcnt vmcnt(29)
    ds_write_b64 v29, v[30:31] offset:0
    buffer_load_dwordx4 v45, s[56:59], s97 offen offset:1024 nt lds
    s_waitcnt vmcnt(29)
    buffer_load_dwordx4 v46, s[56:59], s97 offen offset:2048 nt lds
    s_waitcnt vmcnt(29)
    buffer_load_dwordx4 v47, s[56:59], s97 offen offset:3072 nt lds
    s_add_u32 m0, m0, 4096
    s_add_u32 s97, s97, 128
    s_waitcnt vmcnt(29)
    buffer_load_dwordx4 v44, s[56:59], s97 offen offset:0 nt lds
    v_add_u32 v30, 1, v30
    s_waitcnt vmcnt(29)
    ds_write_b64 v29, v[30:31] offset:0
    buffer_load_dwordx4 v45, s[56:59], s97 offen offset:1024 nt lds
    s_waitcnt vmcnt(29)
    buffer_load_dwordx4 v46, s[56:59], s97 offen offset:2048 nt lds
    s_waitcnt vmcnt(29)
    buffer_load_dwordx4 v47, s[56:59], s97 offen offset:3072 nt lds
    s_add_u32 m0, m0, 4096
    s_add_u32 s97, s97, 128
    s_waitcnt vmcnt(29)
    buffer_load_dwordx4 v44, s[56:59], s97 offen offset:0 nt lds
    v_add_u32 v30, 1, v30
    s_waitcnt vmcnt(29)
    ds_write_b64 v29, v[30:31] offset:0
    buffer_load_dwordx4 v45, s[56:59], s97 offen offset:1024 nt lds
    s_waitcnt vmcnt(29)
    buffer_load_dwordx4 v46, s[56:59], s97 offen offset:2048 nt lds
    s_waitcnt vmcnt(29)
    buffer_load_dwordx4 v47, s[56:59], s97 offen offset:3072 nt lds
    s_add_u32 m0, m0, 4096
    v_add_u32 v30, 1, v30
    s_waitcnt vmcnt(28)
    ds_write_b64 v29, v[30:31] offset:0
    v_add_u32 v30, 1, v30
    s_waitcnt vmcnt(24)
    ds_write_b64 v29, v[30:31] offset:0
    v_add_u32 v30, 1, v30
    s_waitcnt vmcnt(20)
    ds_write_b64 v29, v[30:31] offset:0
    v_add_u32 v30, 1, v30
    s_waitcnt vmcnt(16)
    ds_write_b64 v29, v[30:31] offset:0
    v_add_u32 v30, 1, v30
    s_waitcnt vmcnt(12)
    ds_write_b64 v29, v[30:31] offset:0
    v_add_u32 v30, 1, v30
    s_waitcnt vmcnt(8)
    ds_write_b64 v29, v[30:31] offset:0
    v_add_u32 v30, 1, v30
    s_waitcnt vmcnt(4)
    ds_write_b64 v29, v[30:31] offset:0
    v_add_u32 v30, 1, v30
    s_waitcnt vmcnt(0)
    ds_write_b64 v29, v[30:31] offset:0
L_ld_done:
    s_endpgm
L_notloader:
    v_and_b32 v5, 15, v0
    v_lshlrev_b32 v6, 4, v0
    s_mov_b64 s[48:49], s[38:39]
    s_mov_b32 s50, 268435456
    s_mov_b32 s51, 0x20000
    s_mov_b32 s96, 0
    s_mov_b32 s97, -1
    s_cmp_eq_u32 s3, 5
    s_cbranch_scc1 L_helper
    s_cmp_gt_u32 s3, 5
    s_cbranch_scc1 L_ticket
    s_setprio 1
    v_lshrrev_b32 v12, 2, v5
    v_lshl_add_u32 v13, v4, 2, v12
    v_bfe_u32 v12, v13, 1, 2
    v_lshlrev_b32 v12, 5, v12
    v_lshl_add_u32 v12, v13, 7, v12
    v_and_b32 v13, 3, v0
    v_lshl_add_u32 v7, v13, 3, v12
    s_waitcnt lgkmcnt(0)
    s_add_u32 s13, s13, 0x01010101
    s_movk_i32 s63, 0xff
    v_bfe_i32 v12, v0, 0, 1
    v_and_b32 v12, 1522771305, v12
    v_xor_b32 v12, s13, v12
    v_bfe_u32 v8, v12, 0, 8
    v_bfe_u32 v9, v12, 8, 8
    v_bfe_u32 v10, v12, 16, 8
    v_bfe_u32 v11, v12, 24, 8
    s_waitcnt vmcnt(0)
    s_bfe_u32 s5, s2, 0x30003
    s_lshr_b32 s5, s5, 2
    s_lshl_b32 s5, s5, 3
    s_and_b32 s4, s2, 7
    s_add_u32 s6, s5, s4
    s_cmp_lg_u32 s6, 0
    s_cbranch_scc1 L_nozero
    s_lshr_b32 s5, s2, 3
    s_add_u32 s5, s5, s2
    s_and_b32 s5, s5, 3
    s_lshr_b32 s4, s2, 6
    s_lshl_b32 s4, s4, 2
    s_add_u32 s6, s4, s5
    v_lshlrev_b32 v13, 10, v0
    v_and_b32 v12, 0x2000, v13
    v_add_u32 v13, v13, v12
    v_mov_b32 v12, 0
    s_mul_i32 s7, s6, 256
    s_add_u32 s7, s7, 3407872
    s_mov_b64 exec, 1
    s_cmp_eq_u32 s3, 0
    s_cbranch_scc1 L_dozero
    s_mov_b64 exec, 0xffff
    s_lshr_b32 s4, s6, 2
    s_and_b32 s5, s6, 3
    s_lshl_b32 s7, s5, 15
    s_lshl_b32 s8, s4, 8
    s_add_u32 s7, s7, s8
    s_add_u32 s7, s7, 3801088
    v_mov_b32 v12, s13
    v_lshlrev_b32 v12, 5, v12
    s_cmp_eq_u32 s3, 2
    s_cbranch_scc0 L_zeroed
L_dozero:
    buffer_store_dword v12, v13, s[48:51], s7 offen sc1
L_zeroed:
    s_mov_b64 exec, -1
L_nozero:
    v_lshlrev_b32 v32, 16, v56
    v_and_b32 v33, 0xffff0000, v56
    v_lshlrev_b32 v34, 16, v57
    v_and_b32 v35, 0xffff0000, v57
    v_lshlrev_b32 v36, 16, v58
    v_and_b32 v37, 0xffff0000, v58
    v_lshlrev_b32 v38, 16, v59
    v_and_b32 v39, 0xffff0000, v59
    v_lshlrev_b32 v40, 16, v60
    v_and_b32 v41, 0xffff0000, v60
    v_lshlrev_b32 v42, 16, v61
    v_and_b32 v43, 0xffff0000, v61
    v_lshlrev_b32 v44, 16, v62
    v_and_b32 v45, 0xffff0000, v62
    v_lshlrev_b32 v46, 16, v63
    v_and_b32 v47, 0xffff0000, v63
    v_add_f32 v16, v32, v33
    v_add_f32 v17, v34, v35
    v_add_f32 v16, v16, v36
    v_add_f32 v17, v17, v37
    v_add_f32 v16, v16, v38
    v_add_f32 v17, v17, v39
    v_add_f32 v16, v16, v40
    v_add_f32 v17, v17, v41
    v_add_f32 v16, v16, v42
    v_add_f32 v17, v17, v43
    v_add_f32 v16, v16, v44
    v_add_f32 v17, v17, v45
    v_add_f32 v16, v16, v46
    v_add_f32 v17, v17, v47
    v_add_f32 v16, v16, v17
    s_nop 1
    v_add_f32_dpp v16, v16, v16 row_ror:1 row_mask:0xf bank_mask:0xf
    s_nop 1
    v_add_f32_dpp v16, v16, v16 row_ror:2 row_mask:0xf bank_mask:0xf
    s_nop 1
    v_add_f32_dpp v16, v16, v16 row_ror:4 row_mask:0xf bank_mask:0xf
    s_nop 1
    v_add_f32_dpp v16, v16, v16 row_ror:8 row_mask:0xf bank_mask:0xf
    v_mov_b32 v17, v16
    s_nop 1
    v_permlane16_swap_b32 v16, v17
    v_add_f32 v16, v16, v17
    v_mov_b32 v17, v16
    s_nop 1
    v_permlane32_swap_b32 v16, v17
    v_add_f32 v16, v16, v17
    v_mul_f32 v16, 0x3a800000, v16
    v_sub_f32 v32, v32, v16
    v_sub_f32 v33, v33, v16
    v_sub_f32 v34, v34, v16
    v_sub_f32 v35, v35, v16
    v_sub_f32 v36, v36, v16
    v_sub_f32 v37, v37, v16
    v_sub_f32 v38, v38, v16
    v_sub_f32 v39, v39, v16
    v_sub_f32 v40, v40, v16
    v_sub_f32 v41, v41, v16
    v_sub_f32 v42, v42, v16
    v_sub_f32 v43, v43, v16
    v_sub_f32 v44, v44, v16
    v_sub_f32 v45, v45, v16
    v_sub_f32 v46, v46, v16
    v_sub_f32 v47, v47, v16
    v_mul_f32 v17, v32, v32
    v_mul_f32 v18, v33, v33
    v_fmac_f32 v17, v34, v34
    v_fmac_f32 v18, v35, v35
    v_fmac_f32 v17, v36, v36
    v_fmac_f32 v18, v37, v37
    v_fmac_f32 v17, v38, v38
    v_fmac_f32 v18, v39, v39
    v_fmac_f32 v17, v40, v40
    v_fmac_f32 v18, v41, v41
    v_fmac_f32 v17, v42, v42
    v_fmac_f32 v18, v43, v43
    v_fmac_f32 v17, v44, v44
    v_fmac_f32 v18, v45, v45
    v_fmac_f32 v17, v46, v46
    v_fmac_f32 v18, v47, v47
    v_add_f32 v17, v17, v18
    s_nop 1
    v_add_f32_dpp v17, v17, v17 row_ror:1 row_mask:0xf bank_mask:0xf
    s_nop 1
    v_add_f32_dpp v17, v17, v17 row_ror:2 row_mask:0xf bank_mask:0xf
    s_nop 1
    v_add_f32_dpp v17, v17, v17 row_ror:4 row_mask:0xf bank_mask:0xf
    s_nop 1
    v_add_f32_dpp v17, v17, v17 row_ror:8 row_mask:0xf bank_mask:0xf
    v_mov_b32 v18, v17
    s_nop 1
    v_permlane16_swap_b32 v17, v18
    v_add_f32 v17, v17, v18
    v_mov_b32 v18, v17
    s_nop 1
    v_permlane32_swap_b32 v17, v18
    v_add_f32 v17, v17, v18
    v_mul_f32 v17, 0x3a800000, v17
    v_cvt_pk_bf16_f32 v16, 0, v16
    v_cvt_pk_bf16_f32 v17, 0, v17
    v_add_f32 v17, 0x3727c5ac, v17
    v_cvt_pk_bf16_f32 v17, 0, v17
    v_sqrt_f32 v17, v17
    v_lshlrev_b32 v18, 16, v64
    v_and_b32 v19, 0xffff0000, v64
    v_lshlrev_b32 v20, 16, v65
    v_and_b32 v21, 0xffff0000, v65
    v_cvt_pk_bf16_f32 v17, 0, v17
    v_rcp_f32 v17, v17
    v_sub_f32 v18, v18, v16
    v_sub_f32 v19, v19, v16
    v_sub_f32 v20, v20, v16
    v_sub_f32 v21, v21, v16
    v_cvt_pk_bf16_f32 v18, 0, v18
    v_cvt_pk_bf16_f32 v19, 0, v19
    v_cvt_pk_bf16_f32 v20, 0, v20
    v_cvt_pk_bf16_f32 v21, 0, v21
    v_mul_f32 v18, v18, v17
    v_mul_f32 v19, v19, v17
    v_mul_f32 v20, v20, v17
    v_mul_f32 v21, v21, v17
    v_cvt_pk_bf16_f32 v18, v18, v19
    v_cvt_pk_bf16_f32 v19, v20, v21
    v_add_u32 v15, v15, v1
    ds_write_b64 v15, v[18:19] offset:768
    v_lshl_add_u32 v14, v4, 4, v1
    ds_read_b128 v[32:35], v14 offset:768
    ds_read_b128 v[36:39], v14 offset:832
    ds_read_b128 v[40:43], v14 offset:896
    ds_read_b128 v[44:47], v14 offset:960
    ds_read_b128 v[48:51], v14 offset:1024
    ds_read_b128 v[52:55], v14 offset:1088
    ds_read_b128 v[56:59], v14 offset:1152
    ds_read_b128 v[60:63], v14 offset:1216
    v_lshl_add_u32 v12, v0, 2, v1
    v_add_u32 v12, 5888, v12
    v_cmp_eq_u32 vcc, 0, v0
    s_nop 1
    v_cndmask_b32 v27, v12, v1, vcc
    s_lshl_b32 s4, s3, 2
    v_add_u32 v28, s4, v27
    s_lshl_b32 s4, s3, 5
    v_xor_b32 v14, s4, v7
    s_lshl_b32 s8, s14, 14
    s_lshl_b32 s9, s3, 6
    s_add_u32 s8, s8, s9
    s_lshr_b32 s4, s2, 6
    s_mul_i32 s4, s4, 56
    s_and_b32 s5, s2, 63
    s_add_u32 s4, s4, s5
    s_lshr_b32 s11, s4, 2
    s_mov_b32 s27, 7168
    s_cmp_ge_u32 s11, 28
    s_cselect_b32 s27, 4294960128, s27
    s_add_u32 s27, s27, 0x10000
    s_lshl_b32 s11, s11, 8
    s_add_u32 s11, s11, s8
    s_add_u32 s11, s11, 65536
    s_lshr_b32 s9, s2, 3
    s_lshl_b32 s4, s2, 1
    s_and_b32 s4, s4, 8
    s_xor_b32 s9, s9, s4
    s_xor_b32 s9, s9, 4
    s_and_b32 s9, s9, 15
    s_lshr_b32 s4, s2, 6
    s_lshl4_add_u32 s9, s4, s9
    s_lshl_b32 s9, s9, 8
    s_add_u32 s9, s9, s8
    s_and_b32 s4, s2, 63
    s_cmp_ge_u32 s4, 56
    s_cselect_b32 s15, 2, 6
    s_mov_b32 s99, 0
    s_mov_b32 s10, 0
    v_lshlrev_b32 v15, 6, v4
    v_and_b32 v15, 3, v0
    v_lshlrev_b32 v15, 6, v15
L_c_blk:
    s_add_u32 s10, s10, 4
    s_cmp_ge_u32 s96, s10
    s_cbranch_scc1 L_got_2
    s_mov_b32 s60, 2000000
L_need_1:
    ds_read_b64 v[12:13], v1 offset:0
    s_sub_u32 s60, s60, 1
    s_waitcnt lgkmcnt(0)
    v_readfirstlane_b32 s96, v12
    v_readfirstlane_b32 s97, v13
    s_cselect_b32 s96, -1, s96
    s_cselect_b32 s97, 0, s97
    s_cmp_lt_u32 s96, s10
    s_cbranch_scc1 L_need_1
L_got_2:
    ds_read_b64_tr_b16 v[64:65], v14 offset:0
    ds_read_b64_tr_b16 v[66:67], v14 offset:2048
    ds_read_b64_tr_b16 v[68:69], v14 offset:4096
    ds_read_b64_tr_b16 v[70:71], v14 offset:6144
    ds_read_b64_tr_b16 v[72:73], v14 offset:8192
    ds_read_b64_tr_b16 v[74:75], v14 offset:10240
    ds_read_b64_tr_b16 v[76:77], v14 offset:12288
    ds_read_b64_tr_b16 v[78:79], v14 offset:14336
    s_waitcnt lgkmcnt(0)
    v_mfma_f32_16x16x32_bf16 v[80:83], v[64:67], v[32:35], 0
    v_mfma_f32_16x16x32_bf16 v[80:83], v[68:71], v[36:39], v[80:83]
    v_mfma_f32_16x16x32_bf16 v[80:83], v[72:75], v[40:43], v[80:83]
    v_mfma_f32_16x16x32_bf16 v[80:83], v[76:79], v[44:47], v[80:83]
    s_add_u32 s99, s99, 1
    v_mov_b32 v29, s99
    ds_write_b32 v28, v29 offset:512
    s_add_u32 s10, s10, 2
    s_cmp_ge_u32 s96, s10
    s_cbranch_scc1 L_got_4
    s_mov_b32 s60, 2000000
L_need_3:
    ds_read_b64 v[12:13], v1 offset:0
    s_sub_u32 s60, s60, 1
    s_waitcnt lgkmcnt(0)
    v_readfirstlane_b32 s96, v12
    v_readfirstlane_b32 s97, v13
    s_cselect_b32 s96, -1, s96
    s_cselect_b32 s97, 0, s97
    s_cmp_lt_u32 s96, s10
    s_cbranch_scc1 L_need_3
L_got_4:
    ds_read_b64_tr_b16 v[64:65], v14 offset:16384
    ds_read_b64_tr_b16 v[66:67], v14 offset:18432
    ds_read_b64_tr_b16 v[68:69], v14 offset:20480
    ds_read_b64_tr_b16 v[70:71], v14 offset:22528
    s_waitcnt lgkmcnt(0)
    v_mfma_f32_16x16x32_bf16 v[80:83], v[64:67], v[48:51], v[80:83]
    v_mfma_f32_16x16x32_bf16 v[80:83], v[68:71], v[52:55], v[80:83]
    s_add_u32 s10, s10, 2
    s_cmp_ge_u32 s96, s10
    s_cbranch_scc1 L_got_6
    s_mov_b32 s60, 2000000
L_need_5:
    ds_read_b64 v[12:13], v1 offset:0
    s_sub_u32 s60, s60, 1
    s_waitcnt lgkmcnt(0)
    v_readfirstlane_b32 s96, v12
    v_readfirstlane_b32 s97, v13
    s_cselect_b32 s96, -1, s96
    s_cselect_b32 s97, 0, s97
    s_cmp_lt_u32 s96, s10
    s_cbranch_scc1 L_need_5
L_got_6:
    ds_read_b64_tr_b16 v[72:73], v14 offset:24576
    ds_read_b64_tr_b16 v[74:75], v14 offset:26624
    ds_read_b64_tr_b16 v[76:77], v14 offset:28672
    ds_read_b64_tr_b16 v[78:79], v14 offset:30720
    s_waitcnt lgkmcnt(0)
    v_mfma_f32_16x16x32_bf16 v[80:83], v[72:75], v[56:59], v[80:83]
    v_mfma_f32_16x16x32_bf16 v[80:83], v[76:79], v[60:63], v[80:83]
    s_add_u32 s99, s99, 1
    v_mov_b32 v29, s99
    ds_write_b32 v28, v29 offset:512
    v_add_u32 v14, 0x8000, v14
    s_nop 3
    ds_bpermute_b32 v80, v15, v80
    ds_bpermute_b32 v81, v15, v81
    ds_bpermute_b32 v82, v15, v82
    ds_bpermute_b32 v83, v15, v83
    s_waitcnt vmcnt(0) lgkmcnt(0)
    v_bfi_b32 v80, s63, v8, v80
    v_bfi_b32 v81, s63, v9, v81
    v_bfi_b32 v82, s63, v10, v82
    v_bfi_b32 v83, s63, v11, v83
    s_mov_b64 exec, 0xf
    buffer_store_dwordx4 v[80:83], v6, s[48:51], s9 offen sc1
    s_mov_b64 exec, -1
    s_mov_b32 s9, s11
    s_add_u32 s11, s11, s27
    s_cmp_lt_u32 s99, s15
    s_cbranch_scc1 L_c_blk
    s_and_b32 s4, s2, 63
    s_cmp_ge_u32 s4, 56
    s_cselect_b32 s4, 24, 32
    s_cmp_ge_u32 s96, s4
    s_cbranch_scc1 L_got_8
    s_mov_b32 s60, 2000000
L_need_7:
    ds_read_b64 v[12:13], v1 offset:0
    s_sub_u32 s60, s60, 1
    s_waitcnt lgkmcnt(0)
    v_readfirstlane_b32 s96, v12
    v_readfirstlane_b32 s97, v13
    s_cselect_b32 s96, -1, s96
    s_cselect_b32 s97, 0, s97
    s_cmp_lt_u32 s96, s4
    s_cbranch_scc1 L_need_7
L_got_8:
    s_lshr_b32 s4, s2, 6
    s_lshl_b32 s4, s4, 12
    s_lshl_b32 s5, s3, 10
    s_add_u32 s52, s4, s5
    s_add_u32 s53, s52, 16384
    s_add_u32 s54, s52, 32768
    s_add_u32 s55, s52, 49152
    buffer_load_dwordx4 v[64:67], v6, s[48:51], s52 offen sc1
    buffer_load_dwordx4 v[68:71], v6, s[48:51], s53 offen sc1
    buffer_load_dwordx4 v[72:75], v6, s[48:51], s54 offen sc1
    buffer_load_dwordx4 v[76:79], v6, s[48:51], s55 offen sc1
    v_lshlrev_b32 v13, 1, v3
    v_add_u32 v12, 0, v4
    v_xor_b32 v12, v12, v13
    v_lshlrev_b32 v12, 4, v12
    v_lshl_add_u32 v112, v5, 8, v12
    v_add_u32 v12, 4, v4
    v_xor_b32 v12, v12, v13
    v_lshlrev_b32 v12, 4, v12
    v_lshl_add_u32 v113, v5, 8, v12
    v_add_u32 v12, 8, v4
    v_xor_b32 v12, v12, v13
    v_lshlrev_b32 v12, 4, v12
    v_lshl_add_u32 v114, v5, 8, v12
    v_add_u32 v12, 12, v4
    v_xor_b32 v12, v12, v13
    v_lshlrev_b32 v12, 4, v12
    v_lshl_add_u32 v115, v5, 8, v12
    v_lshrrev_b32 v12, 2, v5
    v_lshl_add_u32 v12, v4, 2, v12
    v_and_b32 v15, 3, v0
    v_lshlrev_b32 v13, 3, v15
    v_lshl_add_u32 v13, v12, 8, v13
    v_add_u32 v13, 8192, v13
    v_and_b32 v12, 7, v12
    s_lshl_b32 s4, s3, 1
    s_add_u32 s5, s4, 0
    v_xor_b32 v14, s5, v12
    v_lshl_add_u32 v116, v14, 5, v13
    s_add_u32 s5, s4, 1
    v_xor_b32 v14, s5, v12
    v_lshl_add_u32 v117, v14, 5, v13
    v_mov_b32 v24, 0xff7fffff
    v_mov_b32 v25, 0
    v_mov_b32 v80, 0
    v_mov_b32 v81, 0
    v_mov_b32 v82, 0
    v_mov_b32 v83, 0
    v_mov_b32 v84, 0
    v_mov_b32 v85, 0
    v_mov_b32 v86, 0
    v_mov_b32 v87, 0
    v_cmp_lt_u32 s[100:101], 7, v5
    s_mov_b32 s12, 1069066811
    v_mul_u32_u24 v14, 272, v3
    v_lshl_add_u32 v14, v4, 4, v14
    v_add_u32 v140, v14, v1
    v_mov_b32 v141, 1
    v_lshlrev_b32 v14, 9, v2
    v_lshl_add_u32 v128, v3, 4, v14
    v_lshlrev_b32 v13, 4, v15
    v_and_b32 v14, 4, v0
    v_lshl_add_u32 v13, v14, 1, v13
    v_add_u32 v13, v13, v2
    v_lshlrev_b32 v129, 2, v13
    v_lshlrev_b32 v130, 3, v4
    v_bfe_i32 v12, v0, 4, 1
    v_and_b32 v12, 1522771305, v12
    v_xor_b32 v143, s13, v12
    v_lshrrev_b32 v144, 8, v143
    v_lshrrev_b32 v145, 16, v143
    s_mul_i32 s4, s2, 4224
    s_lshl_b32 s5, s3, 7
    s_add_u32 s4, s4, s5
    s_add_u32 s44, s4, 1048576
    s_and_b32 s4, s2, 7
    s_lshr_b32 s62, s2, 5
    s_lshl_b32 s62, s62, 3
    s_or_b32 s4, s4, s62
    s_bfe_u32 s5, s2, 0x20003
    s_mul_i32 s8, s4, 4224
    s_lshl_b32 s9, s5, 10
    s_add_u32 s8, s8, s9
    s_lshl_b32 s9, s3, 8
    s_add_u32 s8, s8, s9
    s_add_u32 s45, s8, 262144
    s_lshr_b32 s8, s4, 4
    s_mul_i32 s8, s8, 270336
    s_and_b32 s9, s4, 15
    s_lshl_b32 s9, s9, 8
    s_add_u32 s8, s8, s9
    s_lshl_b32 s9, s3, 6
    s_add_u32 s8, s8, s9
    s_add_u32 s16, s8, 1048576
    s_add_u32 s17, s16, 4224
    s_add_u32 s18, s16, 8448
    s_add_u32 s19, s16, 12672
    v_lshrrev_b32 v13, 2, v0
    v_mul_u32_u24 v13, 16896, v13
    v_lshl_add_u32 v131, v15, 4, v13
    v_lshl_add_u32 v12, v4, 4, v1
    v_add_u32 v12, 1792, v12
    v_add_u32 v13, 576, v1
    v_mov_b32 v147, v12
    v_mov_b32 v12, 0xffffff00
    v_mov_b32 v13, 0
    v_cmp_eq_u32 vcc, 0, v15
    s_nop 1
    v_cndmask_b32 v148, v13, v12, vcc
    v_cmp_eq_u32 vcc, 1, v15
    s_nop 1
    v_cndmask_b32 v149, v13, v12, vcc
    v_cmp_eq_u32 vcc, 2, v15
    s_nop 1
    v_cndmask_b32 v150, v13, v12, vcc
    v_cmp_eq_u32 vcc, 3, v15
    s_nop 1
    v_cndmask_b32 v151, v13, v12, vcc
    s_lshl_b32 s4, s3, 5
    v_lshl_add_u32 v13, v4, 1, v1
    v_lshl_add_u32 v13, v15, 3, v13
    v_add_u32 v132, s4, v13
    v_lshlrev_b32 v13, 4, v5
    v_lshl_add_u32 v133, v4, 6, v13
    v_and_b32 v12, 1, v0
    v_cmp_eq_u32 vcc, 1, v12
    v_mov_b32 v12, 0x06020400
    v_mov_b32 v13, 0x03070105
    v_cndmask_b32 v138, v12, v13, vcc
    v_and_b32 v12, 2, v0
    v_cmp_eq_u32 vcc, 2, v12
    v_mov_b32 v12, 0x05040100
    v_mov_b32 v13, 0x03020706
    v_cndmask_b32 v139, v12, v13, vcc
    s_mov_b32 s20, 0x0c0c0400
    s_mov_b32 s21, 0x05040100
    s_mov_b32 s60, 2000000
    s_branch L_q_wait
L_q_9:
    buffer_load_dwordx4 v[64:67], v6, s[48:51], s52 offen sc1
    buffer_load_dwordx4 v[68:71], v6, s[48:51], s53 offen sc1
    buffer_load_dwordx4 v[72:75], v6, s[48:51], s54 offen sc1
    buffer_load_dwordx4 v[76:79], v6, s[48:51], s55 offen sc1
L_q_wait:
    s_waitcnt vmcnt(0)
    v_xor_b32 v64, v64, v8
    v_xor_b32 v65, v65, v9
    v_xor_b32 v66, v66, v10
    v_xor_b32 v67, v67, v11
    v_xor_b32 v68, v68, v8
    v_xor_b32 v69, v69, v9
    v_xor_b32 v70, v70, v10
    v_xor_b32 v71, v71, v11
    v_xor_b32 v72, v72, v8
    v_xor_b32 v73, v73, v9
    v_xor_b32 v74, v74, v10
    v_xor_b32 v75, v75, v11
    v_xor_b32 v76, v76, v8
    v_xor_b32 v77, v77, v9
    v_xor_b32 v78, v78, v10
    v_xor_b32 v79, v79, v11
    v_or3_b32 v12, v64, v65, v66
    v_or3_b32 v12, v12, v67, v68
    v_or3_b32 v12, v12, v69, v70
    v_or3_b32 v12, v12, v71, v72
    v_or3_b32 v12, v12, v73, v74
    v_or3_b32 v12, v12, v75, v76
    v_or3_b32 v12, v12, v77, v78
    v_or3_b32 v12, v12, v79, v79
    v_and_b32 v12, 0xff, v12
    s_nop 1
    v_or_b32_dpp v12, v12, v12 quad_perm:[1,0,3,2] row_mask:0xf bank_mask:0xf
    s_nop 1
    v_or_b32_dpp v12, v12, v12 quad_perm:[2,3,0,1] row_mask:0xf bank_mask:0xf
    v_cmp_ne_u32 vcc, 0, v12
    s_nop 0
    s_and_b64 exec, exec, vcc
    s_cbranch_execz L_qd_10
    s_sleep 4
    s_sub_u32 s60, s60, 1
    s_cbranch_scc0 L_q_9
L_qd_10:
    s_mov_b64 exec, -1
    v_add_f32 v64, v64, v68
    v_add_f32 v65, v65, v69
    v_add_f32 v66, v66, v70
    v_add_f32 v67, v67, v71
    v_add_f32 v72, v72, v76
    v_add_f32 v73, v73, v77
    v_add_f32 v74, v74, v78
    v_add_f32 v75, v75, v79
    v_add_f32 v64, v64, v72
    v_add_f32 v65, v65, v73
    v_add_f32 v66, v66, v74
    v_add_f32 v67, v67, v75
    v_cvt_pk_bf16_f32 v64, v64, v65
    v_cvt_pk_bf16_f32 v65, v66, v67
    v_lshrrev_b32 v12, 5, v0
    s_lshl_b32 s4, s3, 1
    v_add_u32 v12, s4, v12
    v_mul_u32_u24 v12, 272, v12
    v_and_b32 v13, 31, v0
    v_lshl_add_u32 v12, v13, 3, v12
    v_add_u32 v12, v12, v1
    ds_write_b64 v12, v[64:65] offset:2048
    ds_add_u32 v27, v141 offset:528
    s_mov_b32 s60, 2000000
L_spin_11:
    ds_read_b32 v12, v1 offset:528
    s_sub_u32 s60, s60, 1
    s_waitcnt lgkmcnt(0)
    v_readfirstlane_b32 s61, v12
    s_nop 0
    s_cselect_b32 s61, -1, s61
    s_cmp_lt_u32 s61, 4
    s_cbranch_scc1 L_spin_11
    ds_read_b128 v[96:99], v140 offset:2048
    ds_read_b128 v[100:103], v140 offset:2112
    ds_read_b128 v[104:107], v140 offset:2176
    ds_read_b128 v[108:111], v140 offset:2240
    s_and_b32 s4, s2, 63
    s_cmp_ge_u32 s4, 56
    s_cselect_b32 s25, 7, 6
    s_mov_b32 s11, 0
    s_mov_b32 s26, 0x07060302
    v_add_u32 v146, v6, v1
L_c_kk:
    s_add_u32 s10, s10, 4
    s_cmp_ge_u32 s96, s10
    s_cbranch_scc1 L_got_13
    s_mov_b32 s60, 2000000
L_need_12:
    ds_read_b64 v[12:13], v1 offset:0
    s_sub_u32 s60, s60, 1
    s_waitcnt lgkmcnt(0)
    v_readfirstlane_b32 s96, v12
    v_readfirstlane_b32 s97, v13
    s_cselect_b32 s96, -1, s96
    s_cselect_b32 s97, 0, s97
    s_cmp_lt_u32 s96, s10
    s_cbranch_scc1 L_need_12
L_got_13:
    s_and_b32 s4, s99, 7
    s_lshl_b32 s4, s4, 14
    v_add_u32 v120, s4, v112
    v_add_u32 v121, s4, v113
    v_add_u32 v122, s4, v114
    v_add_u32 v123, s4, v115
    ds_read_b128 v[32:35], v120 offset:0
    ds_read_b128 v[36:39], v121 offset:0
    ds_read_b128 v[40:43], v122 offset:0
    ds_read_b128 v[44:47], v123 offset:0
    ds_read_b128 v[48:51], v120 offset:4096
    ds_read_b128 v[52:55], v121 offset:4096
    ds_read_b128 v[56:59], v122 offset:4096
    ds_read_b128 v[60:63], v123 offset:4096
    ds_read_b128 v[152:155], v120 offset:8192
    ds_read_b128 v[156:159], v121 offset:8192
    ds_read_b128 v[160:163], v122 offset:8192
    ds_read_b128 v[164:167], v123 offset:8192
    ds_read_b128 v[168:171], v120 offset:12288
    ds_read_b128 v[172:175], v121 offset:12288
    ds_read_b128 v[176:179], v122 offset:12288
    ds_read_b128 v[180:183], v123 offset:12288
    s_add_u32 s99, s99, 1
    s_add_u32 s11, s11, 1
    s_waitcnt lgkmcnt(8)
    v_mfma_f32_16x16x32_bf16 v[64:67], v[32:35], v[96:99], 0
    v_mfma_f32_16x16x32_bf16 v[64:67], v[36:39], v[100:103], v[64:67]
    v_mfma_f32_16x16x32_bf16 v[64:67], v[40:43], v[104:107], v[64:67]
    v_mfma_f32_16x16x32_bf16 v[64:67], v[44:47], v[108:111], v[64:67]
    v_mfma_f32_16x16x32_bf16 v[68:71], v[48:51], v[96:99], 0
    v_mfma_f32_16x16x32_bf16 v[68:71], v[52:55], v[100:103], v[68:71]
    v_mfma_f32_16x16x32_bf16 v[68:71], v[56:59], v[104:107], v[68:71]
    v_mfma_f32_16x16x32_bf16 v[68:71], v[60:63], v[108:111], v[68:71]
    s_waitcnt lgkmcnt(0)
    v_mov_b32 v29, s99
    ds_write_b32 v28, v29 offset:512
    v_mfma_f32_16x16x32_bf16 v[72:75], v[152:155], v[96:99], 0
    v_mfma_f32_16x16x32_bf16 v[72:75], v[156:159], v[100:103], v[72:75]
    v_mfma_f32_16x16x32_bf16 v[72:75], v[160:163], v[104:107], v[72:75]
    v_mfma_f32_16x16x32_bf16 v[72:75], v[164:167], v[108:111], v[72:75]
    s_nop 0
    v_cndmask_b32 v16, v64, v68, s[100:101]
    v_mfma_f32_16x16x32_bf16 v[76:79], v[168:171], v[96:99], 0
    v_cndmask_b32 v17, v65, v69, s[100:101]
    v_cndmask_b32 v18, v66, v70, s[100:101]
    v_cndmask_b32 v19, v67, v71, s[100:101]
    v_mfma_f32_16x16x32_bf16 v[76:79], v[172:175], v[100:103], v[76:79]
    v_cvt_pk_bf16_f32 v16, 0, v16
    v_cvt_pk_bf16_f32 v17, 0, v17
    v_cvt_pk_bf16_f32 v18, 0, v18
    v_mfma_f32_16x16x32_bf16 v[76:79], v[176:179], v[104:107], v[76:79]
    v_cvt_pk_bf16_f32 v19, 0, v19
    v_mul_f32 v16, 1035273459, v16
    v_mul_f32 v17, 1035273459, v17
    v_mfma_f32_16x16x32_bf16 v[76:79], v[180:183], v[108:111], v[76:79]
    v_mul_f32 v18, 1035273459, v18
    v_mul_f32 v19, 1035273459, v19
    v_cvt_pk_bf16_f32 v16, 0, v16
    v_cvt_pk_bf16_f32 v17, 0, v17
    v_cvt_pk_bf16_f32 v18, 0, v18
    v_cvt_pk_bf16_f32 v19, 0, v19
    v_max3_f32 v24, v24, v16, v17
    v_perm_b32 v92, v17, v16, s26
    v_max3_f32 v24, v24, v18, v19
    v_perm_b32 v93, v19, v18, s26
    v_cndmask_b32 v88, v72, v76, s[100:101]
    v_cndmask_b32 v89, v73, v77, s[100:101]
    v_cndmask_b32 v90, v74, v78, s[100:101]
    v_cndmask_b32 v91, v75, v79, s[100:101]
    v_cvt_pk_bf16_f32 v88, 0, v88
    v_cvt_pk_bf16_f32 v89, 0, v89
    v_cvt_pk_bf16_f32 v90, 0, v90
    v_cvt_pk_bf16_f32 v91, 0, v91
    v_mul_f32 v88, 1035273459, v88
    v_mul_f32 v89, 1035273459, v89
    v_mul_f32 v90, 1035273459, v90
    v_mul_f32 v91, 1035273459, v91
    v_cvt_pk_bf16_f32 v88, 0, v88
    v_cvt_pk_bf16_f32 v89, 0, v89
    v_cvt_pk_bf16_f32 v90, 0, v90
    v_cvt_pk_bf16_f32 v91, 0, v91
    v_max3_f32 v24, v24, v88, v89
    v_perm_b32 v94, v89, v88, s26
    v_max3_f32 v24, v24, v90, v91
    v_perm_b32 v95, v91, v90, s26
    ds_write_b128 v146, v[92:95] offset:6912
    v_add_u32 v146, 1024, v146
    s_cmp_lt_u32 s11, s25
    s_cbranch_scc1 L_c_kk
    v_max_f32_dpp v24, v24, v24 row_ror:8 row_mask:0xf bank_mask:0xf
    v_mov_b32 v15, v24
    s_nop 1
    v_permlane16_swap_b32 v24, v15
    v_max_f32 v24, v24, v15
    v_mov_b32 v15, v24
    s_nop 1
    v_permlane32_swap_b32 v24, v15
    v_max_f32 v24, v24, v15
    v_mul_f32 v24, s12, v24
    v_add_u32 v146, v6, v1
    s_lshl_b32 s25, s25, 1
L_c_vv:
    ds_read_b128 v[92:95], v146 offset:6912
    v_add_u32 v146, 1024, v146
    s_and_b32 s5, s99, 7
    s_lshl_b32 s5, s5, 14
    s_sub_u32 s5, s5, 8192
    v_add_u32 v118, s5, v116
    v_add_u32 v119, s5, v117
    s_add_u32 s10, s10, 4
    s_add_u32 s99, s99, 1
    s_add_u32 s11, s11, 1
    s_waitcnt lgkmcnt(0)
    v_lshlrev_b32 v16, 16, v92
    v_and_b32 v17, 0xffff0000, v92
    v_lshlrev_b32 v18, 16, v93
    v_and_b32 v19, 0xffff0000, v93
    v_lshlrev_b32 v88, 16, v94
    v_and_b32 v89, 0xffff0000, v94
    v_lshlrev_b32 v90, 16, v95
    v_and_b32 v91, 0xffff0000, v95
    v_fma_f32 v16, v16, s12, -v24
    v_fma_f32 v17, v17, s12, -v24
    v_fma_f32 v18, v18, s12, -v24
    v_fma_f32 v19, v19, s12, -v24
    v_fma_f32 v88, v88, s12, -v24
    v_fma_f32 v89, v89, s12, -v24
    v_fma_f32 v90, v90, s12, -v24
    v_fma_f32 v91, v91, s12, -v24
    s_cmp_ge_u32 s96, s10
    s_cbranch_scc1 L_got_15
    s_mov_b32 s60, 2000000
L_need_14:
    ds_read_b64 v[12:13], v1 offset:0
    s_sub_u32 s60, s60, 1
    s_waitcnt lgkmcnt(0)
    v_readfirstlane_b32 s96, v12
    v_readfirstlane_b32 s97, v13
    s_cselect_b32 s96, -1, s96
    s_cselect_b32 s97, 0, s97
    s_cmp_lt_u32 s96, s10
    s_cbranch_scc1 L_need_14
L_got_15:
    ds_read_b64_tr_b16 v[72:73], v118 offset:0
    ds_read_b64_tr_b16 v[74:75], v118 offset:4096
    ds_read_b64_tr_b16 v[76:77], v119 offset:0
    ds_read_b64_tr_b16 v[78:79], v119 offset:4096
    ds_read_b64_tr_b16 v[152:153], v118 offset:8192
    ds_read_b64_tr_b16 v[154:155], v118 offset:12288
    ds_read_b64_tr_b16 v[156:157], v119 offset:8192
    ds_read_b64_tr_b16 v[158:159], v119 offset:12288
    v_exp_f32 v16, v16
    v_exp_f32 v17, v17
    v_exp_f32 v18, v18
    v_exp_f32 v19, v19
    v_exp_f32 v88, v88
    v_exp_f32 v89, v89
    v_exp_f32 v90, v90
    v_exp_f32 v91, v91
    v_cvt_pk_bf16_f32 v20, v16, v17
    v_cvt_pk_bf16_f32 v21, v18, v19
    v_cvt_pk_bf16_f32 v160, v88, v89
    v_cvt_pk_bf16_f32 v161, v90, v91
    v_add_f32 v16, v16, v88
    v_add_f32 v17, v17, v89
    v_add_f32 v18, v18, v90
    v_add_f32 v19, v19, v91
    v_mov_b32_dpp v22, v20 row_ror:8 row_mask:0xf bank_mask:0xf
    v_mov_b32_dpp v23, v21 row_ror:8 row_mask:0xf bank_mask:0xf
    v_mov_b32_dpp v162, v160 row_ror:8 row_mask:0xf bank_mask:0xf
    v_mov_b32_dpp v163, v161 row_ror:8 row_mask:0xf bank_mask:0xf
    v_add_f32 v16, v16, v17
    v_add_f32 v18, v18, v19
    s_waitcnt lgkmcnt(0)
    v_mov_b32 v29, s99
    ds_write_b32 v28, v29 offset:512
    v_mfma_f32_16x16x32_bf16 v[80:83], v[72:75], v[20:23], v[80:83]
    v_mfma_f32_16x16x32_bf16 v[84:87], v[76:79], v[20:23], v[84:87]
    v_mfma_f32_16x16x32_bf16 v[80:83], v[152:155], v[160:163], v[80:83]
    v_mfma_f32_16x16x32_bf16 v[84:87], v[156:159], v[160:163], v[84:87]
    v_add_f32 v16, v16, v18
    v_add_f32 v25, v25, v16
    s_cmp_lt_u32 s11, s25
    s_cbranch_scc1 L_c_vv
    s_add_u32 s10, s10, 2
    s_cmp_lt_u32 s11, s97
    s_cbranch_scc1 L_c_k
    v_mov_b32 v30, v25
    s_nop 1
    v_add_f32_dpp v30, v30, v30 row_ror:8 row_mask:0xf bank_mask:0xf
    v_mov_b32 v15, v30
    s_nop 1
    v_permlane16_swap_b32 v30, v15
    v_add_f32 v30, v30, v15
    v_mov_b32 v15, v30
    s_nop 1
    v_permlane32_swap_b32 v30, v15
    v_add_f32 v30, v30, v15
    v_log_f32 v31, v30
    v_rcp_f32 v30, v30
    s_sub_u32 s6, s10, 2
    v_add_f32 v31, v31, v24
    v_lshrrev_b32 v31, v130, v31
    s_branch L_c_pub
L_c_fast:
    s_and_b32 s5, s99, 7
    s_lshl_b32 s5, s5, 14
    s_add_u32 s99, s99, 1
    s_and_b32 s4, s99, 7
    s_lshl_b32 s4, s4, 14
    v_add_u32 v118, s5, v116
    v_add_u32 v119, s5, v117
    ds_read_b64_tr_b16 v[72:73], v118 offset:0
    ds_read_b64_tr_b16 v[74:75], v118 offset:4096
    ds_read_b64_tr_b16 v[76:77], v119 offset:0
    ds_read_b64_tr_b16 v[78:79], v119 offset:4096
    v_add_u32 v120, s4, v112
    v_add_u32 v121, s4, v113
    v_add_u32 v122, s4, v114
    v_add_u32 v123, s4, v115
    ds_read_b128 v[32:35], v120 offset:0
    ds_read_b128 v[36:39], v121 offset:0
    ds_read_b128 v[40:43], v122 offset:0
    ds_read_b128 v[44:47], v123 offset:0
    ds_read_b128 v[48:51], v120 offset:4096
    ds_read_b128 v[52:55], v121 offset:4096
    ds_read_b128 v[56:59], v122 offset:4096
    ds_read_b128 v[60:63], v123 offset:4096
    v_cndmask_b32 v16, v64, v68, s[100:101]
    v_cndmask_b32 v17, v65, v69, s[100:101]
    v_cndmask_b32 v18, v66, v70, s[100:101]
    v_cndmask_b32 v19, v67, v71, s[100:101]
    v_cvt_pk_bf16_f32 v16, 0, v16
    v_cvt_pk_bf16_f32 v17, 0, v17
    v_cvt_pk_bf16_f32 v18, 0, v18
    v_cvt_pk_bf16_f32 v19, 0, v19
    v_mul_f32 v16, 1035273459, v16
    v_mul_f32 v17, 1035273459, v17
    v_mul_f32 v18, 1035273459, v18
    v_mul_f32 v19, 1035273459, v19
    v_cvt_pk_bf16_f32 v16, 0, v16
    v_cvt_pk_bf16_f32 v17, 0, v17
    v_cvt_pk_bf16_f32 v18, 0, v18
    v_cvt_pk_bf16_f32 v19, 0, v19
    v_max3_f32 v14, v16, v17, v18
    v_max_f32 v14, v14, v19
    s_waitcnt lgkmcnt(0)
    v_mov_b32 v29, s99
    ds_write_b32 v28, v29 offset:512
    v_mfma_f32_16x16x32_bf16 v[64:67], v[32:35], v[96:99], 0
    v_max_f32_dpp v14, v14, v14 row_ror:8 row_mask:0xf bank_mask:0xf
    v_mov_b32 v15, v14
    v_mfma_f32_16x16x32_bf16 v[64:67], v[36:39], v[100:103], v[64:67]
    s_nop 0
    v_permlane16_swap_b32 v14, v15
    v_max_f32 v14, v14, v15
    v_mov_b32 v15, v14
    v_mfma_f32_16x16x32_bf16 v[64:67], v[40:43], v[104:107], v[64:67]
    v_mfma_f32_16x16x32_bf16 v[64:67], v[44:47], v[108:111], v[64:67]
    v_permlane32_swap_b32 v14, v15
    v_max_f32 v14, v14, v15
    v_mul_f32 v14, s12, v14
    v_max_f32 v14, v14, v24
    v_mfma_f32_16x16x32_bf16 v[68:71], v[48:51], v[96:99], 0
    v_sub_f32 v26, v24, v14
    v_mov_b32 v24, v14
    v_exp_f32 v26, v26
    v_mfma_f32_16x16x32_bf16 v[68:71], v[52:55], v[100:103], v[68:71]
    v_fma_f32 v16, v16, s12, -v14
    v_fma_f32 v17, v17, s12, -v14
    v_fma_f32 v18, v18, s12, -v14
    v_fma_f32 v19, v19, s12, -v14
    v_mfma_f32_16x16x32_bf16 v[68:71], v[56:59], v[104:107], v[68:71]
    v_exp_f32 v16, v16
    v_exp_f32 v17, v17
    v_exp_f32 v18, v18
    v_exp_f32 v19, v19
    v_mfma_f32_16x16x32_bf16 v[68:71], v[60:63], v[108:111], v[68:71]
    v_mul_f32 v80, v26, v80
    v_mul_f32 v81, v26, v81
    v_mul_f32 v82, v26, v82
    v_mul_f32 v83, v26, v83
    v_cvt_pk_bf16_f32 v20, v16, v17
    v_cvt_pk_bf16_f32 v21, v18, v19
    v_mul_f32 v84, v26, v84
    v_mul_f32 v85, v26, v85
    v_mul_f32 v86, v26, v86
    v_mul_f32 v87, v26, v87
    v_mov_b32_dpp v22, v20 row_ror:8 row_mask:0xf bank_mask:0xf
    v_mov_b32_dpp v23, v21 row_ror:8 row_mask:0xf bank_mask:0xf
    v_add_f32 v14, v16, v17
    v_add_f32 v15, v18, v19
    v_add_f32 v14, v14, v15
    v_fma_f32 v25, v25, v26, v14
    v_mfma_f32_16x16x32_bf16 v[80:83], v[72:75], v[20:23], v[80:83]
    v_mfma_f32_16x16x32_bf16 v[84:87], v[76:79], v[20:23], v[84:87]
L_c_top:
    s_add_u32 s11, s11, 1
    s_add_u32 s10, s10, 4
    s_cmp_ge_u32 s11, s97
    s_cbranch_scc1 L_c_slow
    s_cmp_ge_u32 s96, s10
    s_cbranch_scc1 L_c_fast
    ds_read_b64 v[12:13], v1 offset:0
    s_waitcnt lgkmcnt(0)
    v_readfirstlane_b32 s96, v12
    v_readfirstlane_b32 s97, v13
    s_cmp_ge_u32 s96, s10
    s_cbranch_scc1 L_c_fast
L_c_slow:
    s_and_b32 s5, s99, 7
    s_lshl_b32 s5, s5, 14
    v_add_u32 v118, s5, v116
    v_add_u32 v119, s5, v117
    v_cndmask_b32 v16, v64, v68, s[100:101]
    v_cndmask_b32 v17, v65, v69, s[100:101]
    v_cndmask_b32 v18, v66, v70, s[100:101]
    v_cndmask_b32 v19, v67, v71, s[100:101]
    v_cvt_pk_bf16_f32 v16, 0, v16
    v_cvt_pk_bf16_f32 v17, 0, v17
    v_cvt_pk_bf16_f32 v18, 0, v18
    v_cvt_pk_bf16_f32 v19, 0, v19
    v_mul_f32 v16, 1035273459, v16
    v_mul_f32 v17, 1035273459, v17
    v_mul_f32 v18, 1035273459, v18
    v_mul_f32 v19, 1035273459, v19
    v_cvt_pk_bf16_f32 v16, 0, v16
    v_cvt_pk_bf16_f32 v17, 0, v17
    v_cvt_pk_bf16_f32 v18, 0, v18
    v_cvt_pk_bf16_f32 v19, 0, v19
    v_max3_f32 v14, v16, v17, v18
    v_max_f32 v14, v14, v19
    s_nop 1
    v_max_f32_dpp v14, v14, v14 row_ror:8 row_mask:0xf bank_mask:0xf
    v_mov_b32 v15, v14
    s_nop 1
    v_permlane16_swap_b32 v14, v15
    v_max_f32 v14, v14, v15
    v_mov_b32 v15, v14
    s_nop 1
    v_permlane32_swap_b32 v14, v15
    v_max_f32 v14, v14, v15
    v_mul_f32 v14, s12, v14
    v_max_f32 v14, v14, v24
    v_sub_f32 v26, v24, v14
    v_mov_b32 v24, v14
    v_exp_f32 v26, v26
    v_fma_f32 v16, v16, s12, -v14
    v_fma_f32 v17, v17, s12, -v14
    v_fma_f32 v18, v18, s12, -v14
    v_fma_f32 v19, v19, s12, -v14
    v_exp_f32 v16, v16
    v_exp_f32 v17, v17
    v_exp_f32 v18, v18
    v_exp_f32 v19, v19
    v_mul_f32 v80, v26, v80
    v_mul_f32 v81, v26, v81
    v_mul_f32 v82, v26, v82
    v_mul_f32 v83, v26, v83
    v_cvt_pk_bf16_f32 v20, v16, v17
    v_cvt_pk_bf16_f32 v21, v18, v19
    v_mul_f32 v84, v26, v84
    v_mul_f32 v85, v26, v85
    v_mul_f32 v86, v26, v86
    v_mul_f32 v87, v26, v87
    v_mov_b32_dpp v22, v20 row_ror:8 row_mask:0xf bank_mask:0xf
    v_mov_b32_dpp v23, v21 row_ror:8 row_mask:0xf bank_mask:0xf
    v_add_f32 v14, v16, v17
    v_add_f32 v15, v18, v19
    v_add_f32 v14, v14, v15
    v_fma_f32 v25, v25, v26, v14
    v_mov_b32 v30, v25
    s_nop 1
    v_add_f32_dpp v30, v30, v30 row_ror:8 row_mask:0xf bank_mask:0xf
    v_mov_b32 v15, v30
    s_nop 1
    v_permlane16_swap_b32 v30, v15
    v_add_f32 v30, v30, v15
    v_mov_b32 v15, v30
    s_nop 1
    v_permlane32_swap_b32 v30, v15
    v_add_f32 v30, v30, v15
    v_log_f32 v31, v30
    v_rcp_f32 v30, v30
    s_sub_u32 s6, s10, 2
    v_add_f32 v31, v31, v24
    v_lshrrev_b32 v31, v130, v31
    s_cmp_ge_u32 s96, s6
    s_cbranch_scc1 L_got_17
    s_mov_b32 s60, 2000000
L_need_16:
    ds_read_b64 v[12:13], v1 offset:0
    s_sub_u32 s60, s60, 1
    s_waitcnt lgkmcnt(0)
    v_readfirstlane_b32 s96, v12
    v_readfirstlane_b32 s97, v13
    s_cselect_b32 s96, -1, s96
    s_cselect_b32 s97, 0, s97
    s_cmp_lt_u32 s96, s6
    s_cbranch_scc1 L_need_16
L_got_17:
    ds_read_b64_tr_b16 v[72:73], v118 offset:0
    ds_read_b64_tr_b16 v[74:75], v118 offset:4096
    ds_read_b64_tr_b16 v[76:77], v119 offset:0
    ds_read_b64_tr_b16 v[78:79], v119 offset:4096
    s_add_u32 s99, s99, 1
    s_cmp_ge_u32 s11, s97
    s_cbranch_scc1 L_c_last
    s_waitcnt lgkmcnt(0)
    v_mfma_f32_16x16x32_bf16 v[80:83], v[72:75], v[20:23], v[80:83]
    v_mfma_f32_16x16x32_bf16 v[84:87], v[76:79], v[20:23], v[84:87]
    v_mov_b32 v29, s99
    ds_write_b32 v28, v29 offset:512
L_c_k:
    s_cmp_ge_u32 s96, s10
    s_cbranch_scc1 L_got_19
    s_mov_b32 s60, 2000000
L_need_18:
    ds_read_b64 v[12:13], v1 offset:0
    s_sub_u32 s60, s60, 1
    s_waitcnt lgkmcnt(0)
    v_readfirstlane_b32 s96, v12
    v_readfirstlane_b32 s97, v13
    s_cselect_b32 s96, -1, s96
    s_cselect_b32 s97, 0, s97
    s_cmp_lt_u32 s96, s10
    s_cbranch_scc1 L_need_18
L_got_19:
    s_and_b32 s4, s99, 7
    s_lshl_b32 s4, s4, 14
    v_add_u32 v120, s4, v112
    v_add_u32 v121, s4, v113
    v_add_u32 v122, s4, v114
    v_add_u32 v123, s4, v115
    ds_read_b128 v[32:35], v120 offset:0
    ds_read_b128 v[36:39], v121 offset:0
    ds_read_b128 v[40:43], v122 offset:0
    ds_read_b128 v[44:47], v123 offset:0
    ds_read_b128 v[48:51], v120 offset:4096
    ds_read_b128 v[52:55], v121 offset:4096
    ds_read_b128 v[56:59], v122 offset:4096
    ds_read_b128 v[60:63], v123 offset:4096
    s_waitcnt lgkmcnt(7)
    v_mfma_f32_16x16x32_bf16 v[64:67], v[32:35], v[96:99], 0
    s_waitcnt lgkmcnt(6)
    v_mfma_f32_16x16x32_bf16 v[64:67], v[36:39], v[100:103], v[64:67]
    s_waitcnt lgkmcnt(5)
    v_mfma_f32_16x16x32_bf16 v[64:67], v[40:43], v[104:107], v[64:67]
    s_waitcnt lgkmcnt(4)
    v_mfma_f32_16x16x32_bf16 v[64:67], v[44:47], v[108:111], v[64:67]
    s_waitcnt lgkmcnt(3)
    v_mfma_f32_16x16x32_bf16 v[68:71], v[48:51], v[96:99], 0
    s_waitcnt lgkmcnt(2)
    v_mfma_f32_16x16x32_bf16 v[68:71], v[52:55], v[100:103], v[68:71]
    s_waitcnt lgkmcnt(1)
    v_mfma_f32_16x16x32_bf16 v[68:71], v[56:59], v[104:107], v[68:71]
    s_waitcnt lgkmcnt(0)
    v_mfma_f32_16x16x32_bf16 v[68:71], v[60:63], v[108:111], v[68:71]
    s_branch L_c_top
L_c_last:
    s_waitcnt lgkmcnt(0)
    v_mfma_f32_16x16x32_bf16 v[80:83], v[72:75], v[20:23], v[80:83]
    v_mfma_f32_16x16x32_bf16 v[84:87], v[76:79], v[20:23], v[84:87]
    v_mov_b32 v29, s99
    ds_write_b32 v28, v29 offset:512
L_c_pub:
    s_nop 5
    v_mov_b32_dpp v80, v84 row_ror:8 row_mask:0xf bank_mask:0xc
    v_mov_b32_dpp v81, v85 row_ror:8 row_mask:0xf bank_mask:0xc
    v_mov_b32_dpp v82, v86 row_ror:8 row_mask:0xf bank_mask:0xc
    v_mov_b32_dpp v83, v87 row_ror:8 row_mask:0xf bank_mask:0xc
    v_mul_f32 v80, v30, v80
    v_mul_f32 v81, v30, v81
    v_mul_f32 v82, v30, v82
    v_mul_f32 v83, v30, v83
    v_bfi_b32 v80, s63, v143, v80
    v_bfi_b32 v81, s63, v144, v81
    v_bfi_b32 v82, s63, v145, v82
    v_bfi_b32 v83, s63, v31, v83
    ds_bpermute_b32 v80, v129, v80
    ds_bpermute_b32 v81, v129, v81
    ds_bpermute_b32 v82, v129, v82
    ds_bpermute_b32 v83, v129, v83
    s_waitcnt lgkmcnt(0)
    buffer_store_dwordx4 v[80:83], v128, s[48:51], s44 offen sc1
    s_lshl_b32 s99, s99, 2
    s_add_u32 s22, s99, s3
    s_add_u32 s22, s22, 8
    s_add_u32 s23, s22, 4
    s_sub_u32 s4, s22, 1
    s_and_b32 s4, s4, 31
    s_lshl_b32 s4, s4, 12
    v_xor_b32 v14, 0, v7
    v_add_u32 v88, s4, v14
    v_xor_b32 v14, 32, v7
    v_add_u32 v89, s4, v14
    v_xor_b32 v14, 64, v7
    v_add_u32 v90, s4, v14
    v_xor_b32 v14, 96, v7
    v_add_u32 v91, s4, v14
    s_sub_u32 s4, s23, 1
    s_and_b32 s4, s4, 31
    s_lshl_b32 s4, s4, 12
    v_xor_b32 v14, 0, v7
    v_add_u32 v92, s4, v14
    v_xor_b32 v14, 32, v7
    v_add_u32 v93, s4, v14
    v_xor_b32 v14, 64, v7
    v_add_u32 v94, s4, v14
    v_xor_b32 v14, 96, v7
    v_add_u32 v95, s4, v14
    s_add_u32 s10, s99, 13
    s_cmp_ge_u32 s96, s10
    s_cbranch_scc1 L_got_21
    s_mov_b32 s60, 2000000
L_need_20:
    ds_read_b64 v[12:13], v1 offset:0
    s_sub_u32 s60, s60, 1
    s_waitcnt lgkmcnt(0)
    v_readfirstlane_b32 s96, v12
    s_nop 0
    s_cselect_b32 s96, -1, s96
    s_cmp_lt_u32 s96, s10
    s_cbranch_scc1 L_need_20
L_got_21:
    buffer_load_dwordx4 v[64:67], v131, s[48:51], s16 offen sc1
    buffer_load_dwordx4 v[68:71], v131, s[48:51], s17 offen sc1
    buffer_load_dwordx4 v[72:75], v131, s[48:51], s18 offen sc1
    buffer_load_dwordx4 v[76:79], v131, s[48:51], s19 offen sc1
    s_cmp_ge_u32 s96, s22
    s_cbranch_scc1 L_got_23
    s_mov_b32 s60, 2000000
L_need_22:
    ds_read_b64 v[12:13], v1 offset:0
    s_sub_u32 s60, s60, 1
    s_waitcnt lgkmcnt(0)
    v_readfirstlane_b32 s96, v12
    s_nop 0
    s_cselect_b32 s96, -1, s96
    s_cmp_lt_u32 s96, s22
    s_cbranch_scc1 L_need_22
L_got_23:
    ds_read_b64_tr_b16 v[32:33], v88 offset:0
    ds_read_b64_tr_b16 v[34:35], v88 offset:2048
    ds_read_b64_tr_b16 v[40:41], v89 offset:0
    ds_read_b64_tr_b16 v[42:43], v89 offset:2048
    ds_read_b64_tr_b16 v[48:49], v90 offset:0
    ds_read_b64_tr_b16 v[50:51], v90 offset:2048
    ds_read_b64_tr_b16 v[56:57], v91 offset:0
    ds_read_b64_tr_b16 v[58:59], v91 offset:2048
    s_cmp_ge_u32 s96, s23
    s_cbranch_scc1 L_got_25
    s_mov_b32 s60, 2000000
L_need_24:
    ds_read_b64 v[12:13], v1 offset:0
    s_sub_u32 s60, s60, 1
    s_waitcnt lgkmcnt(0)
    v_readfirstlane_b32 s96, v12
    s_nop 0
    s_cselect_b32 s96, -1, s96
    s_cmp_lt_u32 s96, s23
    s_cbranch_scc1 L_need_24
L_got_25:
    ds_read_b64_tr_b16 v[36:37], v92 offset:0
    ds_read_b64_tr_b16 v[38:39], v92 offset:2048
    ds_read_b64_tr_b16 v[44:45], v93 offset:0
    ds_read_b64_tr_b16 v[46:47], v93 offset:2048
    ds_read_b64_tr_b16 v[52:53], v94 offset:0
    ds_read_b64_tr_b16 v[54:55], v94 offset:2048
    ds_read_b64_tr_b16 v[60:61], v95 offset:0
    ds_read_b64_tr_b16 v[62:63], v95 offset:2048
    s_mov_b32 s60, 2000000
L_o_chk:
    s_waitcnt vmcnt(3)
    v_xor_b32 v152, v64, v8
    v_xor_b32 v153, v65, v9
    v_xor_b32 v154, v66, v10
    v_or3_b32 v12, v152, v153, v154
    s_waitcnt vmcnt(2)
    v_xor_b32 v156, v68, v8
    v_xor_b32 v157, v69, v9
    v_xor_b32 v158, v70, v10
    v_or3_b32 v12, v12, v156, v157
    v_perm_b32 v16, v71, v67, s20
    s_waitcnt vmcnt(1)
    v_xor_b32 v160, v72, v8
    v_xor_b32 v161, v73, v9
    v_xor_b32 v162, v74, v10
    v_or3_b32 v12, v12, v158, v160
    v_or3_b32 v12, v12, v161, v162
    s_waitcnt vmcnt(0)
    v_perm_b32 v17, v79, v75, s20
    v_perm_b32 v16, v17, v16, s21
    v_xor_b32 v164, v76, v8
    v_xor_b32 v165, v77, v9
    v_mov_b32_dpp v17, v16 quad_perm:[1,0,3,2] row_mask:0xf bank_mask:0xf
    v_perm_b32 v16, v17, v16, v138
    v_xor_b32 v166, v78, v10
    v_or3_b32 v12, v12, v164, v165
    v_mov_b32_dpp v17, v16 quad_perm:[2,3,0,1] row_mask:0xf bank_mask:0xf
    v_bitop3_b32 v12, v12, v166, s63 bitop3:0xa8
    v_perm_b32 v18, v17, v16, v139
    s_nop 0
    v_or_b32_dpp v12, v12, v12 quad_perm:[1,0,3,2] row_mask:0xf bank_mask:0xf
    v_max_f32_dpp v16, v18, v18 row_ror:1 row_mask:0xf bank_mask:0xf
    s_nop 0
    v_or_b32_dpp v12, v12, v12 quad_perm:[2,3,0,1] row_mask:0xf bank_mask:0xf
    v_max_f32_dpp v16, v16, v16 row_ror:2 row_mask:0xf bank_mask:0xf
    v_cmp_ne_u32 vcc, 0, v12
    s_nop 0
    v_max_f32_dpp v16, v16, v16 row_ror:4 row_mask:0xf bank_mask:0xf
    s_cbranch_vccnz L_o_again
L_o_done:
    ds_add_u32 v27, v141 offset:548
    v_max_f32_dpp v16, v16, v16 row_ror:8 row_mask:0xf bank_mask:0xf
    v_mov_b32 v17, v16
    s_nop 1
    v_permlane16_swap_b32 v16, v17
    v_max_f32 v16, v16, v17
    v_mov_b32 v17, v16
    s_nop 1
    v_permlane32_swap_b32 v16, v17
    v_max_f32 v16, v16, v17
    v_sub_f32 v18, v18, v16
    v_exp_f32 v18, v18
    s_nop 1
    v_mul_f32_dpp v20, v18, v152 quad_perm:[0,0,0,0] row_mask:0xf bank_mask:0xf
    v_mul_f32_dpp v21, v18, v153 quad_perm:[0,0,0,0] row_mask:0xf bank_mask:0xf
    v_mul_f32_dpp v22, v18, v154 quad_perm:[0,0,0,0] row_mask:0xf bank_mask:0xf
    v_mul_f32_dpp v23, v18, v67 quad_perm:[0,0,0,0] row_mask:0xf bank_mask:0xf
    v_add_f32_dpp v16, v18, v18 row_ror:1 row_mask:0xf bank_mask:0xf
    v_fmac_f32_dpp v20, v18, v156 quad_perm:[1,1,1,1] row_mask:0xf bank_mask:0xf
    v_fmac_f32_dpp v21, v18, v157 quad_perm:[1,1,1,1] row_mask:0xf bank_mask:0xf
    v_fmac_f32_dpp v22, v18, v158 quad_perm:[1,1,1,1] row_mask:0xf bank_mask:0xf
    v_fmac_f32_dpp v23, v18, v71 quad_perm:[1,1,1,1] row_mask:0xf bank_mask:0xf
    v_add_f32_dpp v16, v16, v16 row_ror:2 row_mask:0xf bank_mask:0xf
    v_fmac_f32_dpp v20, v18, v160 quad_perm:[2,2,2,2] row_mask:0xf bank_mask:0xf
    v_fmac_f32_dpp v21, v18, v161 quad_perm:[2,2,2,2] row_mask:0xf bank_mask:0xf
    v_fmac_f32_dpp v22, v18, v162 quad_perm:[2,2,2,2] row_mask:0xf bank_mask:0xf
    v_fmac_f32_dpp v23, v18, v75 quad_perm:[2,2,2,2] row_mask:0xf bank_mask:0xf
    v_add_f32_dpp v16, v16, v16 row_ror:4 row_mask:0xf bank_mask:0xf
    v_fmac_f32_dpp v20, v18, v164 quad_perm:[3,3,3,3] row_mask:0xf bank_mask:0xf
    v_fmac_f32_dpp v21, v18, v165 quad_perm:[3,3,3,3] row_mask:0xf bank_mask:0xf
    v_fmac_f32_dpp v22, v18, v166 quad_perm:[3,3,3,3] row_mask:0xf bank_mask:0xf
    v_fmac_f32_dpp v23, v18, v79 quad_perm:[3,3,3,3] row_mask:0xf bank_mask:0xf
    v_add_f32_dpp v16, v16, v16 row_ror:8 row_mask:0xf bank_mask:0xf
    v_mov_b32 v17, v16
    v_permlane32_swap_b32 v20, v22
    v_permlane32_swap_b32 v21, v23
    v_add_f32 v20, v20, v22
    v_add_f32 v21, v21, v23
    v_permlane16_swap_b32 v16, v17
    v_add_f32 v16, v16, v17
    v_permlane16_swap_b32 v20, v21
    v_add_f32 v20, v20, v21
    v_mov_b32 v17, v16
    s_nop 0
    v_add_f32_dpp v20, v20, v20 row_ror:4 row_mask:0xf bank_mask:0xf
    v_permlane32_swap_b32 v16, v17
    v_add_f32 v16, v16, v17
    v_add_f32_dpp v20, v20, v20 row_ror:8 row_mask:0xf bank_mask:0xf
    v_rcp_f32 v16, v16
    s_nop 0
    v_mul_f32 v20, v20, v16
    v_cvt_pk_bf16_f32 v20, v20, v20
    ds_write_b16 v132, v20 offset:1792
    ds_add_u32 v27, v141 offset:532
    s_mov_b32 s60, 2000000
L_x:
    ds_read_b32 v12, v1 offset:532
    ds_read_b128 v[96:99], v147 offset:0
    ds_read_b128 v[100:103], v147 offset:64
    s_sub_u32 s60, s60, 1
    s_waitcnt lgkmcnt(2)
    v_readfirstlane_b32 s61, v12
    s_nop 0
    s_cselect_b32 s61, -1, s61
    s_cmp_lt_u32 s61, 4
    s_cbranch_scc1 L_x
    s_waitcnt lgkmcnt(0)
    v_mfma_f32_16x16x32_bf16 v[104:107], v[32:35], v[96:99], 0
    v_mfma_f32_16x16x32_bf16 v[104:107], v[36:39], v[100:103], v[104:107]
    s_nop 1
    v_mfma_f32_16x16x32_bf16 v[108:111], v[40:43], v[96:99], 0
    s_nop 1
    v_mfma_f32_16x16x32_bf16 v[108:111], v[44:47], v[100:103], v[108:111]
    s_nop 0
    v_mfma_f32_16x16x32_bf16 v[112:115], v[48:51], v[96:99], 0
    v_bfi_b32 v80, v148, v104, v8
    v_bfi_b32 v81, v148, v105, v9
    v_mfma_f32_16x16x32_bf16 v[112:115], v[52:55], v[100:103], v[112:115]
    v_bfi_b32 v82, v148, v106, v10
    v_bfi_b32 v83, v148, v107, v11
    v_mfma_f32_16x16x32_bf16 v[116:119], v[56:59], v[96:99], 0
    v_bfi_b32 v80, v149, v108, v80
    v_bfi_b32 v81, v149, v109, v81
    v_mfma_f32_16x16x32_bf16 v[116:119], v[60:63], v[100:103], v[116:119]
    v_bfi_b32 v82, v149, v110, v82
    v_bfi_b32 v83, v149, v111, v83
    v_bfi_b32 v80, v150, v112, v80
    v_bfi_b32 v81, v150, v113, v81
    v_bfi_b32 v82, v150, v114, v82
    v_bfi_b32 v83, v150, v115, v83
    s_mov_b32 exec_lo, 0xf000f
    s_mov_b32 exec_hi, 0xf000f
    v_bfi_b32 v80, v151, v116, v80
    v_bfi_b32 v81, v151, v117, v81
    v_bfi_b32 v82, v151, v118, v82
    v_bfi_b32 v83, v151, v119, v83
    buffer_store_dwordx4 v[80:83], v133, s[48:51], s45 offen sc1
    s_endpgm
L_o_again:
    s_sub_u32 s60, s60, 1
    s_cbranch_scc1 L_o_done
    s_sleep 1
    s_mov_b64 exec, vcc
    buffer_load_dwordx4 v[64:67], v131, s[48:51], s16 offen sc1
    buffer_load_dwordx4 v[68:71], v131, s[48:51], s17 offen sc1
    buffer_load_dwordx4 v[72:75], v131, s[48:51], s18 offen sc1
    buffer_load_dwordx4 v[76:79], v131, s[48:51], s19 offen sc1
    s_mov_b64 exec, -1
    s_branch L_o_chk
L_helper:
    s_mov_b64 s[56:57], s[34:35]
    s_mov_b32 s58, 2048
    s_mov_b32 s59, 0x20000
    s_add_u32 s13, s13, 0x01010101
    s_movk_i32 s63, 0xff
    v_bfe_i32 v12, v0, 0, 1
    v_and_b32 v12, 1522771305, v12
    v_xor_b32 v12, s13, v12
    v_bfe_u32 v8, v12, 0, 8
    v_bfe_u32 v9, v12, 8, 8
    v_bfe_u32 v10, v12, 16, 8
    v_bfe_u32 v11, v12, 24, 8
    s_lshr_b32 s62, s2, 7
    s_lshl_b32 s62, s62, 3
    s_and_b32 s4, s2, 7
    s_or_b32 s4, s4, s62
    s_mul_i32 s4, s4, 896
    s_add_u32 s8, s4, 65536
    s_add_u32 s9, s8, 0x10000
    v_add_u32 v14, -2, v5
    v_cmp_gt_u32 vcc, 14, v5
    s_nop 1
    v_cndmask_b32 v14, v14, v5, vcc
    v_lshlrev_b32 v15, 4, v14
    v_lshl_add_u32 v15, v4, 14, v15
    v_lshlrev_b32 v14, 3, v14
    v_lshl_add_u32 v14, v4, 1, v14
    v_add_u32 v14, v14, v1
    s_cmp_ge_u32 s96, 64
    s_cbranch_scc1 L_got_27
    s_mov_b32 s60, 2000000
L_need_26:
    s_sleep 8
    ds_read_b64 v[12:13], v1 offset:0
    s_sub_u32 s60, s60, 1
    s_waitcnt lgkmcnt(0)
    v_readfirstlane_b32 s96, v12
    v_readfirstlane_b32 s97, v13
    s_cselect_b32 s96, -1, s96
    s_cselect_b32 s97, 0, s97
    s_cmp_lt_u32 s96, 64
    s_cbranch_scc1 L_need_26
L_got_27:
    s_mov_b32 s60, 2000000
L_h_28:
    buffer_load_dwordx4 v[32:35], v15, s[48:51], s8 offen offset:0 sc1
    buffer_load_dwordx4 v[36:39], v15, s[48:51], s9 offen offset:0 sc1
    buffer_load_dwordx4 v[40:43], v15, s[48:51], s8 offen offset:224 sc1
    buffer_load_dwordx4 v[44:47], v15, s[48:51], s9 offen offset:224 sc1
    buffer_load_dwordx4 v[48:51], v15, s[48:51], s8 offen offset:448 sc1
    buffer_load_dwordx4 v[52:55], v15, s[48:51], s9 offen offset:448 sc1
    buffer_load_dwordx4 v[56:59], v15, s[48:51], s8 offen offset:672 sc1
    buffer_load_dwordx4 v[60:63], v15, s[48:51], s9 offen offset:672 sc1
    s_waitcnt vmcnt(0)
    v_xor_b32 v32, v32, v8
    v_xor_b32 v33, v33, v9
    v_xor_b32 v34, v34, v10
    v_xor_b32 v35, v35, v11
    v_xor_b32 v36, v36, v8
    v_xor_b32 v37, v37, v9
    v_xor_b32 v38, v38, v10
    v_xor_b32 v39, v39, v11
    v_xor_b32 v40, v40, v8
    v_xor_b32 v41, v41, v9
    v_xor_b32 v42, v42, v10
    v_xor_b32 v43, v43, v11
    v_xor_b32 v44, v44, v8
    v_xor_b32 v45, v45, v9
    v_xor_b32 v46, v46, v10
    v_xor_b32 v47, v47, v11
    v_xor_b32 v48, v48, v8
    v_xor_b32 v49, v49, v9
    v_xor_b32 v50, v50, v10
    v_xor_b32 v51, v51, v11
    v_xor_b32 v52, v52, v8
    v_xor_b32 v53, v53, v9
    v_xor_b32 v54, v54, v10
    v_xor_b32 v55, v55, v11
    v_xor_b32 v56, v56, v8
    v_xor_b32 v57, v57, v9
    v_xor_b32 v58, v58, v10
    v_xor_b32 v59, v59, v11
    v_xor_b32 v60, v60, v8
    v_xor_b32 v61, v61, v9
    v_xor_b32 v62, v62, v10
    v_xor_b32 v63, v63, v11
    v_or3_b32 v12, v32, v33, v34
    v_or3_b32 v12, v12, v35, v36
    v_or3_b32 v12, v12, v37, v38
    v_or3_b32 v12, v12, v39, v40
    v_or3_b32 v12, v12, v41, v42
    v_or3_b32 v12, v12, v43, v44
    v_or3_b32 v12, v12, v45, v46
    v_or3_b32 v12, v12, v47, v48
    v_or3_b32 v12, v12, v49, v50
    v_or3_b32 v12, v12, v51, v52
    v_or3_b32 v12, v12, v53, v54
    v_or3_b32 v12, v12, v55, v56
    v_or3_b32 v12, v12, v57, v58
    v_or3_b32 v12, v12, v59, v60
    v_or3_b32 v12, v12, v61, v62
    v_or3_b32 v12, v12, v63, v63
    v_and_b32 v12, 0xff, v12
    s_nop 1
    v_or_b32_dpp v12, v12, v12 quad_perm:[1,0,3,2] row_mask:0xf bank_mask:0xf
    v_cmp_ne_u32 vcc, 0, v12
    s_nop 0
    s_and_b64 exec, exec, vcc
    s_cbranch_execz L_hd_29
    s_sleep 16
    s_sub_u32 s60, s60, 1
    s_cbranch_scc0 L_h_28
L_hd_29:
    s_mov_b64 exec, -1
    v_permlane32_swap_b32 v32, v34
    v_permlane32_swap_b32 v36, v38
    v_permlane32_swap_b32 v40, v42
    v_permlane32_swap_b32 v44, v46
    v_permlane32_swap_b32 v48, v50
    v_permlane32_swap_b32 v52, v54
    v_permlane32_swap_b32 v56, v58
    v_permlane32_swap_b32 v60, v62
    v_permlane32_swap_b32 v33, v35
    v_permlane32_swap_b32 v37, v39
    v_permlane32_swap_b32 v41, v43
    v_permlane32_swap_b32 v45, v47
    v_permlane32_swap_b32 v49, v51
    v_permlane32_swap_b32 v53, v55
    v_permlane32_swap_b32 v57, v59
    v_permlane32_swap_b32 v61, v63
    v_add_f32 v32, v32, v34
    v_add_f32 v36, v36, v38
    v_add_f32 v40, v40, v42
    v_add_f32 v44, v44, v46
    v_add_f32 v48, v48, v50
    v_add_f32 v52, v52, v54
    v_add_f32 v56, v56, v58
    v_add_f32 v60, v60, v62
    v_add_f32 v33, v33, v35
    v_add_f32 v37, v37, v39
    v_add_f32 v41, v41, v43
    v_add_f32 v45, v45, v47
    v_add_f32 v49, v49, v51
    v_add_f32 v53, v53, v55
    v_add_f32 v57, v57, v59
    v_add_f32 v61, v61, v63
    v_permlane16_swap_b32 v32, v33
    v_permlane16_swap_b32 v36, v37
    v_permlane16_swap_b32 v40, v41
    v_permlane16_swap_b32 v44, v45
    v_permlane16_swap_b32 v48, v49
    v_permlane16_swap_b32 v52, v53
    v_permlane16_swap_b32 v56, v57
    v_permlane16_swap_b32 v60, v61
    v_add_f32 v32, v32, v33
    v_add_f32 v36, v36, v37
    v_add_f32 v40, v40, v41
    v_add_f32 v44, v44, v45
    v_add_f32 v48, v48, v49
    v_add_f32 v52, v52, v53
    v_add_f32 v56, v56, v57
    v_add_f32 v60, v60, v61
    v_cvt_pk_bf16_f32 v32, 0, v32
    v_cvt_pk_bf16_f32 v36, 0, v36
    v_cvt_pk_bf16_f32 v40, 0, v40
    v_cvt_pk_bf16_f32 v44, 0, v44
    v_cvt_pk_bf16_f32 v48, 0, v48
    v_cvt_pk_bf16_f32 v52, 0, v52
    v_cvt_pk_bf16_f32 v56, 0, v56
    v_cvt_pk_bf16_f32 v60, 0, v60
    v_mul_f32 v33, 0xbfb8aa3b, v32
    v_mul_f32 v41, 0xbfb8aa3b, v40
    v_mul_f32 v49, 0xbfb8aa3b, v48
    v_mul_f32 v57, 0xbfb8aa3b, v56
    v_exp_f32 v33, v33
    v_exp_f32 v41, v41
    v_exp_f32 v49, v49
    v_exp_f32 v57, v57
    v_add_f32 v33, 1.0, v33
    v_add_f32 v41, 1.0, v41
    v_add_f32 v49, 1.0, v49
    v_add_f32 v57, 1.0, v57
    v_rcp_f32 v33, v33
    v_rcp_f32 v41, v41
    v_rcp_f32 v49, v49
    v_rcp_f32 v57, v57
    v_mul_f32 v33, v33, v32
    v_mul_f32 v41, v41, v40
    v_mul_f32 v49, v49, v48
    v_mul_f32 v57, v57, v56
    v_cvt_pk_bf16_f32 v32, 0, v33
    v_cvt_pk_bf16_f32 v40, 0, v41
    v_cvt_pk_bf16_f32 v48, 0, v49
    v_cvt_pk_bf16_f32 v56, 0, v57
    v_mul_f32 v32, v32, v36
    v_mul_f32 v40, v40, v44
    v_mul_f32 v48, v48, v52
    v_mul_f32 v56, v56, v60
    v_cvt_pk_bf16_f32 v32, v32, v32
    v_cvt_pk_bf16_f32 v40, v40, v40
    v_cvt_pk_bf16_f32 v48, v48, v48
    v_cvt_pk_bf16_f32 v56, v56, v56
    ds_write_b16 v14, v32 offset:1280
    ds_write_b16 v14, v40 offset:1392
    ds_write_b16 v14, v48 offset:1504
    ds_write_b16 v14, v56 offset:1616
    s_and_b32 s4, s2, 3
    s_lshr_b32 s5, s2, 6
    s_lshl2_add_u32 s4, s5, s4
    s_bfe_u32 s5, s2, 0x20004
    s_lshl2_add_u32 s4, s4, s5
    s_lshl_b32 s5, s4, 10
    s_and_b32 s6, s5, 0xe000
    s_add_u32 s5, s5, s6
    s_add_u32 s5, s5, 3801088
    s_add_u32 s52, s38, s5
    s_addc_u32 s53, s39, 0
    s_lshl_b32 s47, s13, 7
    s_add_u32 s47, s47, 64
    s_lshl_b32 s5, s4, 6
    s_add_u32 s20, s5, 262144
    s_add_u32 s21, s5, 266368
    s_add_u32 s22, s5, 270592
    s_add_u32 s23, s5, 274816
    s_lshl_b32 s5, s4, 6
    s_add_u32 s45, s5, 851968
    s_lshr_b32 s46, s4, 2
    s_lshl_b32 s46, s46, 7
    s_and_b32 s5, s4, 3
    s_lshl_b32 s5, s5, 3
    s_add_u32 s46, s46, s5
    v_lshrrev_b32 v12, 2, v0
    v_and_b32 v13, 3, v0
    v_mul_u32_u24 v19, 4224, v12
    v_mul_u32_u24 v18, 16896, v12
    v_lshl_add_u32 v18, v13, 4, v18
    v_lshl_add_u32 v19, v13, 4, v19
    v_lshlrev_b32 v20, 5, v13
    v_lshl_add_u32 v20, v4, 1, v20
    buffer_load_ushort v22, v20, s[40:43], s46 offen
    s_lshr_b32 s62, s2, 7
    s_lshl_b32 s62, s62, 3
    s_and_b32 s4, s2, 7
    s_or_b32 s4, s4, s62
    s_mul_i32 s4, s4, 4224
    s_bfe_u32 s5, s2, 0x40003
    s_lshl_b32 s5, s5, 8
    s_add_u32 s4, s4, s5
    s_add_u32 s15, s4, 851968
    v_lshlrev_b32 v21, 4, v5
    v_lshl_add_u32 v21, v4, 6, v21
    v_lshrrev_b32 v12, 2, v5
    v_lshl_add_u32 v13, v4, 2, v12
    v_bfe_u32 v12, v13, 1, 2
    v_lshlrev_b32 v12, 5, v12
    v_lshl_add_u32 v12, v13, 7, v12
    v_and_b32 v13, 3, v0
    v_lshl_add_u32 v7, v13, 3, v12
    v_xor_b32 v28, 0, v7
    v_xor_b32 v29, 32, v7
    v_xor_b32 v30, 64, v7
    v_xor_b32 v31, 96, v7
    v_lshl_add_u32 v14, v4, 4, v1
    v_and_b32 v12, 1, v0
    v_cmp_eq_u32 s[8:9], 1, v12
    v_and_b32 v12, 2, v0
    v_cmp_eq_u32 s[6:7], 2, v12
    v_mov_b32 v64, 0
    v_mov_b32 v65, 0
    v_mov_b32 v66, 0
    v_mov_b32 v67, 0
    v_mov_b32 v68, 0
    v_mov_b32 v69, 0
    v_mov_b32 v70, 0
    v_mov_b32 v71, 0
    v_mov_b32 v72, 0
    v_mov_b32 v73, 0
    v_mov_b32 v74, 0
    v_mov_b32 v75, 0
    v_mov_b32 v76, 0
    v_mov_b32 v77, 0
    v_mov_b32 v78, 0
    v_mov_b32 v79, 0
    s_mov_b32 s60, 2000000
L_nt_30:
    ds_read_b64 v[12:13], v1 offset:0
    s_waitcnt lgkmcnt(0)
    v_readfirstlane_b32 s96, v12
    v_readfirstlane_b32 s97, v13
    s_nop 0
    s_cmp_lg_u32 s97, -1
    s_cbranch_scc1 L_ntd_31
    s_sleep 4
    s_sub_u32 s60, s60, 1
    s_cbranch_scc0 L_nt_30
L_ntd_31:
    s_and_b32 s4, s2, 63
    s_cmp_ge_u32 s4, 56
    s_cselect_b32 s10, 2, 6
    s_add_u32 s10, s10, s97
    s_lshl_b32 s10, s10, 2
    s_mov_b32 s11, 0
    s_cmp_ge_u32 s96, s10
    s_cbranch_scc1 L_got_33
    s_mov_b32 s60, 2000000
L_need_32:
    s_sleep 2
    ds_read_b64 v[12:13], v1 offset:0
    s_sub_u32 s60, s60, 1
    s_waitcnt lgkmcnt(0)
    v_readfirstlane_b32 s96, v12
    v_readfirstlane_b32 s97, v13
    s_cselect_b32 s96, -1, s96
    s_cselect_b32 s97, 0, s97
    s_cmp_lt_u32 s96, s10
    s_cbranch_scc1 L_need_32
L_got_33:
    s_setprio 2
L_h_step:
    s_and_b32 s4, s10, 31
    s_lshl_b32 s4, s4, 12
    v_add_u32 v24, s4, v28
    v_add_u32 v25, s4, v29
    v_add_u32 v26, s4, v30
    v_add_u32 v27, s4, v31
    ds_read_b128 v[48:51], v14 offset:1280
    v_add_u32 v14, 64, v14
    s_add_u32 s10, s10, 1
    s_cmp_ge_u32 s96, s10
    s_cbranch_scc1 L_got_35
    s_mov_b32 s60, 2000000
L_need_34:
    ds_read_b64 v[12:13], v1 offset:0
    s_sub_u32 s60, s60, 1
    s_waitcnt lgkmcnt(0)
    v_readfirstlane_b32 s96, v12
    v_readfirstlane_b32 s97, v13
    s_cselect_b32 s96, -1, s96
    s_cselect_b32 s97, 0, s97
    s_cmp_lt_u32 s96, s10
    s_cbranch_scc1 L_need_34
L_got_35:
    ds_read_b64_tr_b16 v[32:33], v24 offset:0
    ds_read_b64_tr_b16 v[34:35], v24 offset:2048
    ds_read_b64_tr_b16 v[36:37], v25 offset:0
    ds_read_b64_tr_b16 v[38:39], v25 offset:2048
    ds_read_b64_tr_b16 v[40:41], v26 offset:0
    ds_read_b64_tr_b16 v[42:43], v26 offset:2048
    ds_read_b64_tr_b16 v[44:45], v27 offset:0
    ds_read_b64_tr_b16 v[46:47], v27 offset:2048
    s_waitcnt lgkmcnt(6)
    v_mfma_f32_16x16x32_bf16 v[64:67], v[32:35], v[48:51], v[64:67]
    s_waitcnt lgkmcnt(4)
    v_mfma_f32_16x16x32_bf16 v[68:71], v[36:39], v[48:51], v[68:71]
    s_waitcnt lgkmcnt(2)
    v_mfma_f32_16x16x32_bf16 v[72:75], v[40:43], v[48:51], v[72:75]
    s_waitcnt lgkmcnt(0)
    v_mfma_f32_16x16x32_bf16 v[76:79], v[44:47], v[48:51], v[76:79]
    s_add_u32 s11, s11, 1
    s_cmp_lt_u32 s11, 7
    s_cbranch_scc1 L_h_step
    s_nop 0
    v_cndmask_b32 v64, v64, v68, s[8:9]
    v_cndmask_b32 v65, v65, v69, s[8:9]
    v_cndmask_b32 v66, v66, v70, s[8:9]
    v_cndmask_b32 v67, v67, v71, s[8:9]
    v_cndmask_b32 v72, v72, v76, s[8:9]
    v_cndmask_b32 v73, v73, v77, s[8:9]
    v_cndmask_b32 v74, v74, v78, s[8:9]
    v_cndmask_b32 v75, v75, v79, s[8:9]
    v_cndmask_b32 v64, v64, v72, s[6:7]
    v_cndmask_b32 v65, v65, v73, s[6:7]
    v_cndmask_b32 v66, v66, v74, s[6:7]
    v_cndmask_b32 v67, v67, v75, s[6:7]
    v_bfi_b32 v64, s63, v8, v64
    v_bfi_b32 v65, s63, v9, v65
    v_bfi_b32 v66, s63, v10, v66
    v_bfi_b32 v67, s63, v11, v67
    s_mov_b32 exec_lo, 0xf000f
    s_mov_b32 exec_hi, 0xf000f
    buffer_store_dwordx4 v[64:67], v21, s[48:51], s15 offen sc1
    s_mov_b64 exec, -1
    s_setprio 0
    s_xor_b32 s4, s2, 0
    s_and_b32 s4, s4, 12
    s_cbranch_scc1 L_hend
    s_add_u32 s10, s10, 8
    s_cmp_ge_u32 s96, s10
    s_cbranch_scc1 L_got_37
    s_mov_b32 s60, 2000000
L_need_36:
    s_sleep 1
    ds_read_b64 v[12:13], v1 offset:0
    s_sub_u32 s60, s60, 1
    s_waitcnt lgkmcnt(0)
    v_readfirstlane_b32 s96, v12
    s_nop 0
    s_cselect_b32 s96, -1, s96
    s_cmp_lt_u32 s96, s10
    s_cbranch_scc1 L_need_36
L_got_37:
    s_mov_b32 s60, 2000000
L_h_most:
    s_load_dword s28, s[52:53], 0 glc
    s_load_dword s29, s[52:53], 256 glc
    s_load_dword s30, s[52:53], 512 glc
    s_load_dword s31, s[52:53], 768 glc
    s_sub_u32 s60, s60, 1
    s_cselect_b32 s5, 0, -1
    s_waitcnt lgkmcnt(0)
    s_add_u32 s28, s28, s29
    s_add_u32 s30, s30, s31
    s_sub_u32 s28, s47, s28
    s_sub_u32 s28, s28, s30
    s_and_b32 s28, s28, s5
    s_cmp_gt_u32 s28, 16
    s_cbranch_scc1 L_h_most
    buffer_load_dwordx4 v[96:99], v19, s[48:51], s45 offen sc1
    s_cmp_eq_u32 s28, 0
    s_cbranch_scc1 L_h_go
    s_mov_b32 s24, 0
    s_mov_b32 s25, 0
    s_mov_b32 s26, 0
    s_mov_b32 s27, 0
    s_mov_b32 s28, 0
    s_mov_b32 s29, 0
    s_mov_b32 s30, 0
    s_mov_b32 s31, 0
    s_load_dword s28, s[52:53], 0 glc
    s_load_dword s29, s[52:53], 256 glc
    s_load_dword s30, s[52:53], 512 glc
    s_load_dword s31, s[52:53], 768 glc
    s_sleep 4
L_h_all:
    s_load_dword s24, s[52:53], 0 glc
    s_load_dword s25, s[52:53], 256 glc
    s_load_dword s26, s[52:53], 512 glc
    s_load_dword s27, s[52:53], 768 glc
    s_waitcnt lgkmcnt(4)
    s_and_b64 s[4:5], s[28:29], s[30:31]
    s_and_b32 s4, s4, s5
    s_bitcmp1_b32 s4, 4
    s_cbranch_scc1 L_h_go
    s_load_dword s28, s[52:53], 0 glc
    s_load_dword s29, s[52:53], 256 glc
    s_load_dword s30, s[52:53], 512 glc
    s_load_dword s31, s[52:53], 768 glc
    s_sub_u32 s60, s60, 1
    s_cbranch_scc1 L_h_go
    s_waitcnt lgkmcnt(4)
    s_and_b64 s[4:5], s[24:25], s[26:27]
    s_and_b32 s4, s4, s5
    s_bitcmp1_b32 s4, 4
    s_cbranch_scc0 L_h_all
L_h_go:
    buffer_load_dwordx4 v[80:83], v18, s[48:51], s20 offen sc1
    buffer_load_dwordx4 v[84:87], v18, s[48:51], s21 offen sc1
    buffer_load_dwordx4 v[88:91], v18, s[48:51], s22 offen sc1
    buffer_load_dwordx4 v[92:95], v18, s[48:51], s23 offen sc1
    s_mov_b32 s60, 2000000
    s_waitcnt vmcnt(4)
    s_branch L_f_chk
L_f_38:
    buffer_load_dwordx4 v[96:99], v19, s[48:51], s45 offen sc1
    s_waitcnt vmcnt(0)
L_f_chk:
    v_xor_b32 v96, v96, v8
    v_xor_b32 v97, v97, v9
    v_xor_b32 v98, v98, v10
    v_xor_b32 v99, v99, v11
    v_or3_b32 v12, v96, v97, v98
    v_or3_b32 v12, v12, v99, v99
    v_and_b32 v12, 0xff, v12
    s_nop 1
    v_or_b32_dpp v12, v12, v12 quad_perm:[1,0,3,2] row_mask:0xf bank_mask:0xf
    s_nop 1
    v_or_b32_dpp v12, v12, v12 quad_perm:[2,3,0,1] row_mask:0xf bank_mask:0xf
    v_cmp_ne_u32 vcc, 0, v12
    s_nop 0
    s_and_b64 exec, exec, vcc
    s_cbranch_execz L_fd_39
    s_sub_u32 s60, s60, 1
    s_cbranch_scc0 L_f_38
L_fd_39:
    s_mov_b64 exec, -1
    v_permlane32_swap_b32 v96, v98
    v_permlane32_swap_b32 v97, v99
    v_add_f32 v96, v96, v98
    v_add_f32 v97, v97, v99
    s_nop 1
    v_permlane16_swap_b32 v96, v97
    v_add_f32 v96, v96, v97
    s_nop 1
    v_add_f32_dpp v96, v96, v96 row_ror:4 row_mask:0xf bank_mask:0xf
    s_nop 1
    v_add_f32_dpp v96, v96, v96 row_ror:8 row_mask:0xf bank_mask:0xf
    v_cvt_pk_bf16_f32 v96, 0, v96
    v_mul_f32 v12, 0xbfb8aa3b, v96
    v_exp_f32 v12, v12
    s_nop 0
    v_add_f32 v12, 1.0, v12
    v_rcp_f32 v12, v12
    s_nop 0
    v_mul_f32 v12, v12, v96
    v_cvt_pk_bf16_f32 v96, 0, v12
    v_lshlrev_b32 v22, 16, v22
    s_mov_b32 s60, 2000000
L_s_chk:
    s_waitcnt vmcnt(3)
    v_xor_b32 v100, v80, v8
    v_xor_b32 v101, v81, v9
    v_xor_b32 v102, v82, v10
    v_xor_b32 v103, v83, v11
    v_or3_b32 v12, v100, v101, v102
    v_or3_b32 v12, v12, v103, v103
    s_waitcnt vmcnt(2)
    v_xor_b32 v104, v84, v8
    v_xor_b32 v105, v85, v9
    v_xor_b32 v106, v86, v10
    v_xor_b32 v107, v87, v11
    v_pk_add_f32 v[100:101], v[100:101], v[104:105]
    v_pk_add_f32 v[102:103], v[102:103], v[106:107]
    v_or3_b32 v12, v12, v104, v105
    v_or3_b32 v12, v12, v106, v107
    s_waitcnt vmcnt(1)
    v_xor_b32 v104, v88, v8
    v_xor_b32 v105, v89, v9
    v_xor_b32 v106, v90, v10
    v_xor_b32 v107, v91, v11
    v_pk_add_f32 v[100:101], v[100:101], v[104:105]
    v_pk_add_f32 v[102:103], v[102:103], v[106:107]
    v_or3_b32 v12, v12, v104, v105
    v_or3_b32 v12, v12, v106, v107
    s_waitcnt vmcnt(0)
    v_xor_b32 v104, v92, v8
    v_xor_b32 v105, v93, v9
    v_xor_b32 v106, v94, v10
    v_xor_b32 v107, v95, v11
    v_pk_add_f32 v[100:101], v[100:101], v[104:105]
    v_pk_add_f32 v[102:103], v[102:103], v[106:107]
    v_or3_b32 v12, v12, v104, v105
    v_or3_b32 v12, v12, v106, v107
    v_permlane32_swap_b32 v100, v102
    v_permlane32_swap_b32 v101, v103
    v_pk_add_f32 v[100:101], v[100:101], v[102:103]
    v_and_b32 v12, 0xff, v12
    s_nop 0
    v_permlane16_swap_b32 v100, v101
    v_add_f32 v100, v100, v101
    v_or_b32_dpp v12, v12, v12 quad_perm:[1,0,3,2] row_mask:0xf bank_mask:0xf
    s_nop 0
    v_add_f32_dpp v100, v100, v100 row_ror:4 row_mask:0xf bank_mask:0xf
    v_or_b32_dpp v12, v12, v12 quad_perm:[2,3,0,1] row_mask:0xf bank_mask:0xf
    s_nop 0
    v_add_f32_dpp v100, v100, v100 row_ror:8 row_mask:0xf bank_mask:0xf
    v_cmp_ne_u32 vcc, 0, v12
    v_cvt_pk_bf16_f32 v100, 0, v100
    v_mul_f32 v100, v100, v96
    s_cbranch_vccnz L_s_again
L_s_done:
    v_cvt_pk_bf16_f32 v100, 0, v100
    v_add_f32 v100, v100, v22
    v_cvt_pk_bf16_f32 v80, v100, v100
    s_mov_b32 exec_lo, 0xf000f
    s_mov_b32 exec_hi, 0xf000f
    buffer_store_short v80, v20, s[56:59], s46 offen
L_hend:
    s_endpgm
L_s_again:
    s_sub_u32 s60, s60, 1
    s_cbranch_scc1 L_s_done
    s_mov_b64 exec, vcc
    buffer_load_dwordx4 v[80:83], v18, s[48:51], s20 offen sc1
    buffer_load_dwordx4 v[84:87], v18, s[48:51], s21 offen sc1
    buffer_load_dwordx4 v[88:91], v18, s[48:51], s22 offen sc1
    buffer_load_dwordx4 v[92:95], v18, s[48:51], s23 offen sc1
    s_mov_b64 exec, -1
    s_branch L_s_chk
L_ticket:
    s_cmp_lg_u32 s3, 6
    s_cbranch_scc1 L_t_noent
    s_lshr_b32 s5, s2, 3
    s_add_u32 s5, s5, s2
    s_and_b32 s5, s5, 3
    s_lshr_b32 s4, s2, 6
    s_lshl_b32 s4, s4, 2
    s_add_u32 s11, s4, s5
    s_bfe_u32 s5, s2, 0x30003
    s_lshr_b32 s5, s5, 2
    s_lshl_b32 s5, s5, 3
    s_and_b32 s4, s2, 7
    s_add_u32 s6, s5, s4
    s_and_b32 s4, s2, 63
    s_cmp_ge_u32 s4, 56
    s_cselect_b32 s9, 1, 0
    s_add_u32 s8, s9, 6
    v_subrev_u32 v15, s8, v0
    v_cmp_gt_u32 s[100:101], s8, v0
    s_nop 1
    v_cndmask_b32 v28, v15, v0, s[100:101]
    s_lshl_b32 s4, s9, 4
    s_sub_u32 s6, s6, s4
    v_lshl_add_u32 v15, v28, 4, s6
    s_bfe_u32 s4, s2, 0x10002
    s_add_u32 s4, s4, 96
    v_lshl_add_u32 v31, v28, 1, s4
    v_cmp_gt_u32 vcc, s9, v28
    s_nop 1
    v_cndmask_b32 v15, v15, v31, vcc
    s_mul_i32 s6, s11, 16
    v_lshl_add_u32 v15, v15, 1, s6
    v_and_b32 v15, 255, v15
    s_lshl_b32 s7, s11, 21
    v_lshl_add_u32 v15, v15, 13, s7
    v_cndmask_b32 v28, 4, 8, s[100:101]
    v_or_b32 v15, v15, v28
    s_lshl_b32 s9, s9, 1
    v_or_b32 v15, 1, v15
    v_lshl_add_u32 v14, v0, 2, v1
    s_add_u32 s9, s9, 12
    s_bfm_b64 exec, s9, 0
    ds_write_b32 v14, v15 offset:4352
    s_mov_b64 exec, -1
L_t_noent:
    s_lshr_b32 s5, s2, 3
    s_add_u32 s5, s5, s2
    s_and_b32 s5, s5, 3
    s_lshr_b32 s4, s2, 6
    s_lshl_b32 s4, s4, 2
    s_add_u32 s11, s4, s5
    s_mul_i32 s12, s11, 16
    s_lshl_b32 s9, s11, 21
    s_add_u32 s12, s12, 196
    s_or_b32 s9, s9, 1
    s_mul_i32 s11, s11, 256
    s_add_u32 s11, s11, 3407872
    s_add_u32 s56, s38, s11
    s_addc_u32 s57, s39, 0
    s_add_u32 s10, s3, 6
    s_and_b32 s4, s2, 63
    s_cmp_ge_u32 s4, 56
    s_cselect_b32 s4, 2, 0
    s_add_u32 s10, s10, s4
    s_mov_b32 s60, 2000000
    s_branch L_spe_41
L_spin_40:
    s_sleep 8
L_spe_41:
    ds_read_b32 v12, v1 offset:528
    s_sub_u32 s60, s60, 1
    s_waitcnt lgkmcnt(0)
    v_readfirstlane_b32 s61, v12
    s_nop 0
    s_cselect_b32 s61, -1, s61
    s_cmp_lt_u32 s61, 4
    s_cbranch_scc1 L_spin_40
    s_and_b32 s4, s2, 63
    s_lshl_b32 s4, s4, 3
    s_or_b32 s4, s4, s3
    s_cmp_lg_u32 s4, 7
    s_cbranch_scc1 L_t_next
    s_mov_b32 s15, 1
    s_atomic_add s15, s[36:37], 64 glc
    s_add_u32 s13, s13, 0x01010101
    v_mov_b32 v15, s13
    s_mov_b32 s4, 258048
    s_waitcnt lgkmcnt(0)
    s_and_b32 s15, s15, 3
    s_cmp_lg_u32 s15, 3
    s_cbranch_scc1 L_t_next
    s_mov_b64 exec, 1
    buffer_store_dword v15, v0, s[48:51], s4 offen sc1
    s_mov_b64 exec, -1
L_t_next:
    s_sub_u32 s11, s10, 1
    s_mov_b32 s60, 2000000
    s_branch L_spe_43
L_spin_42:
    s_sleep 1
L_spe_43:
    ds_read_b32 v12, v1 offset:540
    s_sub_u32 s60, s60, 1
    s_waitcnt lgkmcnt(0)
    v_readfirstlane_b32 s61, v12
    s_nop 0
    s_cselect_b32 s61, -1, s61
    s_cmp_lt_u32 s61, s11
    s_cbranch_scc1 L_spin_42
    s_mov_b32 s15, 1
    s_atomic_add s15, s[56:57], 0 glc
    s_lshl_b32 s4, s10, 2
    v_add_u32 v14, s4, v1
    s_waitcnt lgkmcnt(0)
    s_add_u32 s4, s15, s12
    s_and_b32 s4, s4, 255
    s_lshl_b32 s4, s4, 13
    s_add_u32 s4, s4, s9
    s_cmp_lt_u32 s15, 60
    s_cselect_b32 s4, s4, 0
    s_add_u32 s10, s10, 2
    s_cmp_lt_u32 s15, 40
    s_cselect_b32 s5, 0, 2
    v_mov_b32 v15, s4
    v_or_b32 v15, s5, v15
    ds_write_b32 v14, v15 offset:4352
    s_cbranch_scc1 L_t_next
    s_mov_b32 s60, 2000000
L_nt_44:
    ds_read_b64 v[12:13], v1 offset:0
    s_waitcnt lgkmcnt(0)
    v_readfirstlane_b32 s96, v12
    v_readfirstlane_b32 s97, v13
    s_nop 0
    s_cmp_lg_u32 s97, -1
    s_cbranch_scc1 L_ntd_45
    s_sleep 2
    s_sub_u32 s60, s60, 1
    s_cbranch_scc0 L_nt_44
L_ntd_45:
    s_and_b32 s4, s2, 63
    s_cmp_ge_u32 s4, 56
    s_cselect_b32 s10, 2, 6
    s_add_u32 s10, s10, s97
    s_lshl_b32 s10, s10, 2
    s_cmp_eq_u32 s3, 6
    s_cbranch_scc1 L_t_zero
    s_endpgm
L_t_zero:
    s_and_b32 s6, s2, 7
    s_lshr_b32 s62, s2, 5
    s_lshl_b32 s62, s62, 3
    s_or_b32 s6, s6, s62
    s_bfe_u32 s7, s2, 0x20003
    s_lshl_b32 s7, s7, 15
    s_lshr_b32 s5, s2, 6
    s_lshl_b32 s5, s5, 8
    s_add_u32 s7, s7, s5
    s_add_u32 s7, s7, 3801088
    v_mov_b32 v15, 1
    v_lshlrev_b32 v14, 10, v0
    v_and_b32 v12, 0x2000, v14
    v_add_u32 v14, v14, v12
    s_add_u32 s10, s10, 15
    s_cmp_ge_u32 s96, s10
    s_cbranch_scc1 L_got_47
    s_mov_b32 s60, 2000000
L_need_46:
    s_sleep 1
    ds_read_b64 v[12:13], v1 offset:0
    s_sub_u32 s60, s60, 1
    s_waitcnt lgkmcnt(0)
    v_readfirstlane_b32 s96, v12
    v_readfirstlane_b32 s97, v13
    s_cselect_b32 s96, -1, s96
    s_cselect_b32 s97, 0, s97
    s_cmp_lt_u32 s96, s10
    s_cbranch_scc1 L_need_46
L_got_47:
    s_setprio 3
    s_mov_b32 s60, 2000000
L_spin_48:
    ds_read_b32 v12, v1 offset:548
    s_sub_u32 s60, s60, 1
    s_waitcnt lgkmcnt(0)
    v_readfirstlane_b32 s61, v12
    s_nop 0
    s_cselect_b32 s61, -1, s61
    s_cmp_lt_u32 s61, 4
    s_cbranch_scc1 L_spin_48
    s_mov_b64 exec, 0xffff
    buffer_atomic_add v15, v14, s[48:51], s7 offen sc1
L_end:
    s_endpgm
L_codeend:
.section .rodata,"a"
.p2align 6
.amdhsa_kernel recurrent_scan__gqa_block_cached__swiglu_ffn__decode_kernel
  .amdhsa_next_free_vgpr 184
  .amdhsa_next_free_sgpr 102
  .amdhsa_accum_offset 184
  .amdhsa_group_segment_fixed_size 0
  .amdhsa_kernarg_size 96
  .amdhsa_user_sgpr_count 2
  .amdhsa_user_sgpr_kernarg_segment_ptr 1
  .amdhsa_system_sgpr_workgroup_id_x 1
  .amdhsa_float_denorm_mode_32 3
.end_amdhsa_kernel
```
